```python
import torch

def _softmax(x, axis=-1):
    return torch.softmax(x, dim=axis)
def _gelu(x):
    return torch.nn.functional.gelu(x, approximate="tanh")
def _silu(x):
    return torch.nn.functional.silu(x)
def _sigmoid(x):
    return torch.sigmoid(x)
def _layernorm(x, axis=-1, eps=1e-5):
    m = x.mean(dim=axis, keepdim=True)
    v = x.var(dim=axis, keepdim=True, unbiased=False)
    return (x - m) / torch.sqrt(v + eps)
def _scatter_add(tgt, idx, src, axis=0):
    return tgt.clone().index_add_(axis, idx, src)
def _segment_sum(src, seg, n):
    out = torch.zeros((n,) + src.shape[1:], dtype=src.dtype)
    return out.index_add_(0, seg, src)
def _pad(x, pw):
    flat = tuple(v for pair in reversed(pw) for v in pair)
    return torch.nn.functional.pad(x, flat)

kernel_name = 'recurrent_scan__gqa_block_cached__glu_gated_geglu__decode'

def setup_inputs():

    _w = (lambda a: (lambda t: t.to(torch.bfloat16) if t.is_floating_point() else t)(torch.as_tensor(a)))
    def _A_setup():
        B, Sq, D = 2, 1, 448
        Hq, Hkv, Sk, Dh = 16, 8, 32768, 256
        assert Hq % Hkv == 0, (Hq, Hkv)
        return {
            "x": _w((lambda *s: torch.randn(*s, dtype=torch.bfloat16) * 0.4)(B, Sq, D)),
            "k_cache": _w((lambda *s: torch.randn(*s, dtype=torch.bfloat16) * 1.6)(B, Hkv, Sk, Dh)),
            "v_cache": _w((lambda *s: torch.randn(*s, dtype=torch.bfloat16) * 1.6)(B, Hkv, Sk, Dh)),
            "wq": _w((lambda *s: torch.randn(*s, dtype=torch.bfloat16) * 1.6)(D, Hq * Dh) * (D ** -0.5)),
            "wo": _w((lambda *s: torch.randn(*s, dtype=torch.bfloat16) * 1.6)(Hq * Dh, D) * ((Hq * Dh) ** -0.5)),
        }
    _A_in = _A_setup()

    def _B_setup():
        B, S, Dm, Df = 2, 1, 448, 1792
        return {
            "x": _w((lambda *s: torch.randn(*s, dtype=torch.bfloat16) * 0.4)(B, S, Dm)),
            "w_gate": _w((lambda *s: torch.randn(*s, dtype=torch.bfloat16) * 1.6)(Dm, Df) * (Dm ** -0.5)),
            "w_up": _w((lambda *s: torch.randn(*s, dtype=torch.bfloat16) * 1.6)(Dm, Df) * (Dm ** -0.5)),
            "w_down": _w((lambda *s: torch.randn(*s, dtype=torch.bfloat16) * 1.6)(Df, Dm) * (Df ** -0.5)),
        }
    _B_in = _B_setup()

    return {
        "A_x": _A_in["x"],
        "A_k_cache": _A_in["k_cache"],
        "A_v_cache": _A_in["v_cache"],
        "A_wq": _A_in["wq"],
        "A_wo": _A_in["wo"],
        "B_x": _B_in["x"],
        "B_w_gate": _B_in["w_gate"],
        "B_w_up": _B_in["w_up"],
        "B_w_down": _B_in["w_down"],
    }

def reference(A_x, A_k_cache, A_v_cache, A_wq, A_wo, B_x, B_w_gate, B_w_up, B_w_down):
    def _A_ref(x, k_cache, v_cache, wq, wo):
        B, Sq, D = x.shape
        Hq, Dh = 16, 256
        Hkv = k_cache.shape[1]
        rep = Hq // Hkv
        q = (lambda x, *d: x.permute(*d))((x @ wq).reshape(B, Sq, Hq, Dh), 0, 2, 1, 3)
        k = (lambda x, n, axis: torch.repeat_interleave(x, n, dim=axis))(k_cache, rep, axis=1)
        v = (lambda x, n, axis: torch.repeat_interleave(x, n, dim=axis))(v_cache, rep, axis=1)
        scores = torch.einsum("bhqd,bhkd->bhqk", q, k) * (Dh ** -0.5)
        p = _softmax(scores, axis=-1)
        o = torch.einsum("bhqk,bhkd->bhqd", p, v)
        return (lambda x, *d: x.permute(*d))(o, 0, 2, 1, 3).reshape(B, Sq, Hq * Dh) @ wo

    def _B_ref(x, w_gate, w_up, w_down):
        g = torch.einsum("bsd,df->bsf", x, w_gate)
        u = torch.einsum("bsd,df->bsf", x, w_up)
        h = _gelu(g) * u
        return torch.einsum("bsf,fd->bsd", h, w_down)

    x = A_x
    xn = _layernorm(x, axis=-1)
    s = _A_ref(xn, A_k_cache, A_v_cache, A_wq, A_wo)
    g = _silu(_B_ref(xn, B_w_gate, B_w_up, B_w_down))
    return x + s * g
```

```asm
; @launch grid=(256,1,1) block=(512,1,1) lds=87040
.amdgcn_target "amdgcn-amd-amdhsa--gfx950"
.text
.globl recurrent_scan__gqa_block_cached__glu_gated_geglu__decode_kernel
.p2align 8
.type recurrent_scan__gqa_block_cached__glu_gated_geglu__decode_kernel,@function
recurrent_scan__gqa_block_cached__glu_gated_geglu__decode_kernel:
  s_cmp_ge_u32 s2, 256
  s_cbranch_scc1 L_end
  s_load_dwordx16 s[16:31], s[0:1], 0
  s_load_dwordx8 s[32:39], s[0:1], 64
  v_lshrrev_b32 v1, 6, v0
  v_and_b32 v0, 63, v0
  v_readfirstlane_b32 s3, v1
  s_mov_b32 s64, 0x05040100
  s_mov_b32 s65, 0x07060302
  s_mov_b32 s66, 0x3db8aa3b
  s_mov_b32 s67, 0xffff0000
  s_mov_b32 s70, 0xcccccccc
  s_mov_b32 s71, 0xcccccccc
  s_cmp_ge_u32 s3, 4
  s_cbranch_scc1 L_helper
  v_bfe_u32 v8, v0, 1, 2
  v_bfe_u32 v9, v0, 3, 1
  v_lshl_add_u32 v8, v8, 1, v9
  v_lshlrev_b32 v8, 9, v8
  v_lshrrev_b32 v9, 4, v0
  v_and_b32 v10, 1, v0
  v_lshl_add_u32 v10, v9, 1, v10
  v_lshl_add_u32 v1, v10, 4, v8
  v_lshlrev_b32 v2, 4, v0
  s_bfe_u32 s4, s2, 0x40003
  s_lshl_b32 s78, s4, 0
  s_bfe_u32 s4, s2, 0x30000
  s_lshl_b32 s4, s4, 4
  s_or_b32 s78, s78, s4
  s_bfe_u32 s4, s2, 0x10007
  s_lshl_b32 s4, s4, 7
  s_or_b32 s78, s78, s4
  s_bfe_u32 s4, s78, 0x10000
  s_lshl_b32 s44, s4, 15
  s_bfe_u32 s4, s78, 0x70001
  s_lshl_b32 s4, s4, 21
  s_or_b32 s44, s44, s4
  s_bfe_u32 s4, s3, 0x20000
  s_lshl_b32 s4, s4, 12
  s_or_b32 s44, s44, s4
  s_mov_b32 s47, 0
  s_and_b32 s4, s2, 32
  s_bcnt1_i32_b32 s4, s4
  s_and_b32 s4, s4, 1
  s_or_b32 s47, s47, s4
  s_and_b32 s4, s2, 32
  s_bcnt1_i32_b32 s4, s4
  s_and_b32 s4, s4, 1
  s_lshl_b32 s4, s4, 1
  s_or_b32 s47, s47, s4
  s_and_b32 s4, s2, 32
  s_bcnt1_i32_b32 s4, s4
  s_and_b32 s4, s4, 1
  s_lshl_b32 s4, s4, 2
  s_or_b32 s47, s47, s4
  s_and_b32 s4, s2, 32
  s_bcnt1_i32_b32 s4, s4
  s_and_b32 s4, s4, 1
  s_lshl_b32 s4, s4, 3
  s_or_b32 s47, s47, s4
  s_mov_b32 s5, 0
  s_and_b32 s4, s2, 64
  s_bcnt1_i32_b32 s4, s4
  s_and_b32 s4, s4, 1
  s_or_b32 s5, s5, s4
  s_xor_b32 s6, s5, 0
  s_bfe_u32 s4, s6, 0x10000
  s_lshl_b32 s48, s4, 14
  s_bfe_u32 s4, s6, 0x10001
  s_lshl_b32 s4, s4, 16
  s_or_b32 s48, s48, s4
  s_xor_b32 s6, s5, 1
  s_bfe_u32 s4, s6, 0x10000
  s_lshl_b32 s49, s4, 14
  s_bfe_u32 s4, s6, 0x10001
  s_lshl_b32 s4, s4, 16
  s_or_b32 s49, s49, s4
  s_xor_b32 s6, s5, 2
  s_bfe_u32 s4, s6, 0x10000
  s_lshl_b32 s50, s4, 14
  s_bfe_u32 s4, s6, 0x10001
  s_lshl_b32 s4, s4, 16
  s_or_b32 s50, s50, s4
  s_xor_b32 s6, s5, 3
  s_bfe_u32 s4, s6, 0x10000
  s_lshl_b32 s51, s4, 14
  s_bfe_u32 s4, s6, 0x10001
  s_lshl_b32 s4, s4, 16
  s_or_b32 s51, s51, s4
  s_mov_b32 s46, 0
  s_mov_b32 s10, 0x10000000
  s_mov_b32 s11, 0x00020000
  s_mov_b32 s14, 0x10000000
  s_mov_b32 s15, 0x00020000
  s_xor_b32 s45, s46, s47
  s_bfe_u32 s4, s45, 0x40000
  s_lshl_b32 s68, s4, 17
  s_or_b32 s68, s68, s44
  s_add_u32 s46, s46, 1
  s_add_u32 s69, s68, s48
  s_waitcnt lgkmcnt(0)
  s_mov_b32 s8, s18
  s_mov_b32 s9, s19
  buffer_load_dwordx4 v[76:79], v1, s[8:11], s69 offen offset:0 nt
  buffer_load_dwordx4 v[80:83], v1, s[8:11], s69 offen offset:128 nt
  buffer_load_dwordx4 v[84:87], v1, s[8:11], s69 offen offset:256 nt
  buffer_load_dwordx4 v[88:91], v1, s[8:11], s69 offen offset:384 nt
  s_add_u32 s69, s68, s49
  buffer_load_dwordx4 v[92:95], v1, s[8:11], s69 offen offset:0 nt
  buffer_load_dwordx4 v[96:99], v1, s[8:11], s69 offen offset:128 nt
  s_mov_b32 s12, s20
  s_mov_b32 s13, s21
  s_mov_b32 s40, s38
  s_mov_b32 s41, s39
  s_mov_b32 s42, 0x00200000
  s_mov_b32 s43, 0x00020000
  s_load_dword s76, s[38:39], 0
  s_barrier
  v_bfe_u32 v8, v0, 4, 1
  v_bfe_u32 v9, v0, 1, 1
  v_cmp_eq_u32 vcc, v8, v9
  s_nop 1
  v_cndmask_b32 v12, 0, -1, vcc
  v_mov_b32 v4, 0xff800000
  v_mov_b32 v5, 0
  v_mov_b32 v60, 0
  v_mov_b32 v61, 0
  v_mov_b32 v62, 0
  v_mov_b32 v63, 0
  v_mov_b32 v64, 0
  v_mov_b32 v65, 0
  v_mov_b32 v66, 0
  v_mov_b32 v67, 0
  v_bfe_u32 v11, v0, 2, 2
  v_cmp_eq_u32 vcc, 0, v11
  s_nop 1
  v_cndmask_b32 v68, 0, v12, vcc
  v_cmp_eq_u32 vcc, 1, v11
  s_nop 1
  v_cndmask_b32 v69, 0, v12, vcc
  v_cmp_eq_u32 vcc, 2, v11
  s_nop 1
  v_cndmask_b32 v70, 0, v12, vcc
  v_cmp_eq_u32 vcc, 3, v11
  s_nop 1
  v_cndmask_b32 v71, 0, v12, vcc
  v_lshrrev_b32 v8, 4, v0
  v_lshl_add_u32 v8, v8, 1, v9
  v_lshlrev_b32 v8, 4, v8
  v_and_b32 v9, 1, v0
  v_lshl_add_u32 v10, v9, 9, v8
  s_lshl_b32 s4, s3, 14
  s_add_u32 s79, s4, 21504
  v_add_u32 v72, s79, v2
  s_waitcnt vmcnt(5)
  buffer_load_dwordx4 v[100:103], v1, s[8:11], s69 offen offset:256 nt
  s_waitcnt vmcnt(5)
  buffer_load_dwordx4 v[104:107], v1, s[8:11], s69 offen offset:384 nt
  s_add_u32 s69, s68, s50
  s_waitcnt vmcnt(5)
  buffer_load_dwordx4 v[108:111], v1, s[8:11], s69 offen offset:0 nt
  s_waitcnt vmcnt(5)
  buffer_load_dwordx4 v[112:115], v1, s[8:11], s69 offen offset:128 nt
  s_waitcnt vmcnt(5)
  buffer_load_dwordx4 v[116:119], v1, s[8:11], s69 offen offset:256 nt
  s_waitcnt vmcnt(5)
  buffer_load_dwordx4 v[120:123], v1, s[8:11], s69 offen offset:384 nt
  s_add_u32 s69, s68, s51
  s_waitcnt vmcnt(5)
  buffer_load_dwordx4 v[124:127], v1, s[8:11], s69 offen offset:0 nt
  s_waitcnt vmcnt(5)
  buffer_load_dwordx4 v[128:131], v1, s[8:11], s69 offen offset:128 nt
  s_waitcnt vmcnt(5)
  buffer_load_dwordx4 v[132:135], v1, s[8:11], s69 offen offset:256 nt
  s_waitcnt vmcnt(5)
  buffer_load_dwordx4 v[136:139], v1, s[8:11], s69 offen offset:384 nt
  s_xor_b32 s45, s46, s47
  s_bfe_u32 s4, s45, 0x40000
  s_lshl_b32 s68, s4, 17
  s_or_b32 s68, s68, s44
  s_add_u32 s46, s46, 1
  s_add_u32 s69, s68, s48
  s_waitcnt vmcnt(5)
  buffer_load_dwordx4 v[140:143], v1, s[8:11], s69 offen offset:0 nt
  s_waitcnt vmcnt(5)
  buffer_load_dwordx4 v[144:147], v1, s[8:11], s69 offen offset:128 nt
  s_waitcnt vmcnt(5)
  buffer_load_dwordx4 v[148:151], v1, s[8:11], s69 offen offset:256 nt
  s_waitcnt vmcnt(5)
  buffer_load_dwordx4 v[152:155], v1, s[8:11], s69 offen offset:384 nt
  s_add_u32 s69, s68, s49
  s_waitcnt vmcnt(5)
  buffer_load_dwordx4 v[156:159], v1, s[8:11], s69 offen offset:0 nt
  s_waitcnt vmcnt(5)
  buffer_load_dwordx4 v[160:163], v1, s[8:11], s69 offen offset:128 nt
  s_waitcnt vmcnt(5)
  buffer_load_dwordx4 v[164:167], v1, s[8:11], s69 offen offset:256 nt
  s_waitcnt vmcnt(5)
  buffer_load_dwordx4 v[168:171], v1, s[8:11], s69 offen offset:384 nt
  s_add_u32 s69, s68, s50
  s_waitcnt vmcnt(5)
  buffer_load_dwordx4 v[172:175], v1, s[8:11], s69 offen offset:0 nt
  s_waitcnt vmcnt(5)
  buffer_load_dwordx4 v[176:179], v1, s[8:11], s69 offen offset:128 nt
  s_waitcnt vmcnt(5)
  buffer_load_dwordx4 v[180:183], v1, s[8:11], s69 offen offset:256 nt
  s_waitcnt vmcnt(5)
  buffer_load_dwordx4 v[184:187], v1, s[8:11], s69 offen offset:384 nt
  s_add_u32 s69, s68, s51
  s_waitcnt vmcnt(5)
  buffer_load_dwordx4 v[188:191], v1, s[8:11], s69 offen offset:0 nt
  s_waitcnt vmcnt(5)
  buffer_load_dwordx4 v[192:195], v1, s[8:11], s69 offen offset:128 nt
  s_waitcnt vmcnt(5)
  buffer_load_dwordx4 v[196:199], v1, s[8:11], s69 offen offset:256 nt
  s_waitcnt vmcnt(5)
  buffer_load_dwordx4 v[200:203], v1, s[8:11], s69 offen offset:384 nt
  s_xor_b32 s45, s46, s47
  s_bfe_u32 s4, s45, 0x40000
  s_lshl_b32 s68, s4, 17
  s_or_b32 s68, s68, s44
  s_add_u32 s46, s46, 1
  s_add_u32 s69, s68, s48
  s_waitcnt vmcnt(5)
  buffer_load_dwordx4 v[204:207], v1, s[8:11], s69 offen offset:0 nt
  s_waitcnt vmcnt(5)
  buffer_load_dwordx4 v[208:211], v1, s[8:11], s69 offen offset:128 nt
  s_waitcnt vmcnt(5)
  buffer_load_dwordx4 v[212:215], v1, s[8:11], s69 offen offset:256 nt
  s_waitcnt vmcnt(5)
  buffer_load_dwordx4 v[216:219], v1, s[8:11], s69 offen offset:384 nt
  s_add_u32 s69, s68, s49
  s_waitcnt vmcnt(5)
  buffer_load_dwordx4 v[220:223], v1, s[8:11], s69 offen offset:0 nt
  s_waitcnt vmcnt(5)
  buffer_load_dwordx4 v[224:227], v1, s[8:11], s69 offen offset:128 nt
  s_waitcnt vmcnt(5)
  buffer_load_dwordx4 v[228:231], v1, s[8:11], s69 offen offset:256 nt
  s_waitcnt vmcnt(5)
  buffer_load_dwordx4 v[232:235], v1, s[8:11], s69 offen offset:384 nt
  s_waitcnt lgkmcnt(0)
  s_add_u32 s76, s76, 1
  s_and_b32 s60, s76, 0xff
  s_xor_b32 s61, s60, 0xff
  s_lshl_b32 s61, s61, 8
  s_or_b32 s60, s60, s61
  s_lshr_b32 s61, s76, 8
  s_lshl_b32 s61, s61, 16
  s_or_b32 s60, s60, s61
  s_mov_b32 s61, 0x0c0c0400
  s_mov_b32 s62, 0x04000c0c
  s_mov_b32 s63, 0x07060500
  s_mov_b32 s52, 0xffffff00
  s_sub_u32 s53, s2, 32
  s_lshl_b32 s59, s53, 3
  s_lshr_b32 s53, s53, 3
  s_or_b32 s53, s53, s3
  s_and_b32 s59, s59, 63
  s_add_u32 s36, s38, 950272
  s_addc_u32 s37, s39, 0
  s_mov_b32 s72, 15
  s_mov_b32 s73, 0
  s_mov_b32 s77, 0x10000
  s_barrier
  ds_read_b128 v[24:27], v10 offset:256
  ds_read_b128 v[28:31], v10 offset:384
  ds_read_b128 v[32:35], v10 offset:512
  ds_read_b128 v[36:39], v10 offset:640
  s_waitcnt vmcnt(8) lgkmcnt(0)
  v_mfma_f32_16x16x32_bf16 v[40:43], v[76:79], v[24:27], 0
  v_mfma_f32_16x16x32_bf16 v[40:43], v[80:83], v[28:31], v[40:43]
  v_mfma_f32_16x16x32_bf16 v[40:43], v[84:87], v[32:35], v[40:43]
  v_mfma_f32_16x16x32_bf16 v[40:43], v[88:91], v[36:39], v[40:43]
  v_mfma_f32_16x16x32_bf16 v[44:47], v[92:95], v[24:27], 0
  v_mfma_f32_16x16x32_bf16 v[44:47], v[96:99], v[28:31], v[44:47]
  v_mfma_f32_16x16x32_bf16 v[44:47], v[100:103], v[32:35], v[44:47]
  v_mfma_f32_16x16x32_bf16 v[44:47], v[104:107], v[36:39], v[44:47]
  s_nop 3
  v_cndmask_b32 v20, v40, v41, s[70:71]
  v_cndmask_b32 v21, v42, v43, s[70:71]
  s_nop 0
  v_add_f32_dpp v20, v20, v20 quad_perm:[2,3,0,1] row_mask:0xf bank_mask:0xf
  v_add_f32_dpp v21, v21, v21 quad_perm:[2,3,0,1] row_mask:0xf bank_mask:0xf
  v_cvt_pk_bf16_f32 v56, v20, v21
  v_lshlrev_b32 v8, 16, v56
  v_and_b32 v9, s67, v56
  v_mfma_f32_16x16x32_bf16 v[48:51], v[108:111], v[24:27], 0
  v_mfma_f32_16x16x32_bf16 v[48:51], v[112:115], v[28:31], v[48:51]
  v_mfma_f32_16x16x32_bf16 v[48:51], v[116:119], v[32:35], v[48:51]
  v_mfma_f32_16x16x32_bf16 v[48:51], v[120:123], v[36:39], v[48:51]
  s_add_u32 s69, s68, s50
  s_waitcnt vmcnt(5)
  buffer_load_dwordx4 v[108:111], v1, s[8:11], s69 offen offset:0 nt
  s_waitcnt vmcnt(5)
  buffer_load_dwordx4 v[112:115], v1, s[8:11], s69 offen offset:128 nt
  s_waitcnt vmcnt(5)
  buffer_load_dwordx4 v[116:119], v1, s[8:11], s69 offen offset:256 nt
  s_waitcnt vmcnt(5)
  buffer_load_dwordx4 v[120:123], v1, s[8:11], s69 offen offset:384 nt
  v_cndmask_b32 v20, v44, v45, s[70:71]
  v_cndmask_b32 v21, v46, v47, s[70:71]
  s_nop 0
  v_add_f32_dpp v20, v20, v20 quad_perm:[2,3,0,1] row_mask:0xf bank_mask:0xf
  v_add_f32_dpp v21, v21, v21 quad_perm:[2,3,0,1] row_mask:0xf bank_mask:0xf
  v_cvt_pk_bf16_f32 v57, v20, v21
  v_lshlrev_b32 v10, 16, v57
  v_and_b32 v11, s67, v57
  v_mfma_f32_16x16x32_bf16 v[52:55], v[124:127], v[24:27], 0
  v_mfma_f32_16x16x32_bf16 v[52:55], v[128:131], v[28:31], v[52:55]
  v_mfma_f32_16x16x32_bf16 v[52:55], v[132:135], v[32:35], v[52:55]
  v_mfma_f32_16x16x32_bf16 v[52:55], v[136:139], v[36:39], v[52:55]
  v_cndmask_b32 v20, v48, v49, s[70:71]
  v_cndmask_b32 v21, v50, v51, s[70:71]
  s_nop 0
  v_add_f32_dpp v20, v20, v20 quad_perm:[2,3,0,1] row_mask:0xf bank_mask:0xf
  v_add_f32_dpp v21, v21, v21 quad_perm:[2,3,0,1] row_mask:0xf bank_mask:0xf
  v_cvt_pk_bf16_f32 v58, v20, v21
  v_lshlrev_b32 v12, 16, v58
  v_and_b32 v13, s67, v58
  v_mfma_f32_16x16x32_bf16 v[40:43], v[140:143], v[24:27], 0
  v_mfma_f32_16x16x32_bf16 v[40:43], v[144:147], v[28:31], v[40:43]
  v_mfma_f32_16x16x32_bf16 v[40:43], v[148:151], v[32:35], v[40:43]
  v_mfma_f32_16x16x32_bf16 v[40:43], v[152:155], v[36:39], v[40:43]
  v_cndmask_b32 v20, v52, v53, s[70:71]
  v_cndmask_b32 v21, v54, v55, s[70:71]
  s_nop 0
  v_add_f32_dpp v20, v20, v20 quad_perm:[2,3,0,1] row_mask:0xf bank_mask:0xf
  v_add_f32_dpp v21, v21, v21 quad_perm:[2,3,0,1] row_mask:0xf bank_mask:0xf
  v_cvt_pk_bf16_f32 v59, v20, v21
  v_lshlrev_b32 v14, 16, v59
  v_and_b32 v15, s67, v59
  ds_write_b128 v72, v[56:59]
  v_max3_f32 v16, v8, v9, v10
  v_max3_f32 v17, v11, v12, v13
  v_max3_f32 v16, v16, v14, v15
  v_max3_f32 v16, v16, v17, v4
  v_add_u32 v72, 1024, v72
  v_sub_f32 v17, v4, v16
  v_mul_f32 v7, s66, v16
  v_mul_f32 v17, s66, v17
  v_exp_f32 v6, v17
  v_mov_b32 v4, v16
  v_fma_f32 v8, v8, s66, -v7
  v_fma_f32 v9, v9, s66, -v7
  v_fma_f32 v10, v10, s66, -v7
  v_fma_f32 v11, v11, s66, -v7
  v_fma_f32 v12, v12, s66, -v7
  v_fma_f32 v13, v13, s66, -v7
  v_fma_f32 v14, v14, s66, -v7
  v_fma_f32 v15, v15, s66, -v7
  v_exp_f32 v8, v8
  v_exp_f32 v9, v9
  v_exp_f32 v10, v10
  v_exp_f32 v11, v11
  v_exp_f32 v12, v12
  v_exp_f32 v13, v13
  v_exp_f32 v14, v14
  v_exp_f32 v15, v15
  v_add_f32 v16, v8, v9
  v_add_f32 v17, v10, v11
  v_add_f32 v18, v12, v13
  v_add_f32 v19, v14, v15
  v_add_f32 v16, v16, v17
  v_add_f32 v18, v18, v19
  v_add_f32 v16, v16, v18
  v_fma_f32 v5, v5, v6, v16
  s_add_u32 s69, s68, s51
  s_waitcnt vmcnt(5)
  buffer_load_dwordx4 v[124:127], v1, s[8:11], s69 offen offset:0 nt
  v_mfma_f32_16x16x32_bf16 v[44:47], v[156:159], v[24:27], 0
  v_mfma_f32_16x16x32_bf16 v[44:47], v[160:163], v[28:31], v[44:47]
  v_mfma_f32_16x16x32_bf16 v[44:47], v[164:167], v[32:35], v[44:47]
  v_mfma_f32_16x16x32_bf16 v[44:47], v[168:171], v[36:39], v[44:47]
  v_cndmask_b32 v20, v40, v41, s[70:71]
  v_cndmask_b32 v21, v42, v43, s[70:71]
  s_nop 0
  v_add_f32_dpp v20, v20, v20 quad_perm:[2,3,0,1] row_mask:0xf bank_mask:0xf
  v_add_f32_dpp v21, v21, v21 quad_perm:[2,3,0,1] row_mask:0xf bank_mask:0xf
  v_cvt_pk_bf16_f32 v56, v20, v21
  v_lshlrev_b32 v8, 16, v56
  v_and_b32 v9, s67, v56
  v_mfma_f32_16x16x32_bf16 v[48:51], v[172:175], v[24:27], 0
  v_mfma_f32_16x16x32_bf16 v[48:51], v[176:179], v[28:31], v[48:51]
  v_mfma_f32_16x16x32_bf16 v[48:51], v[180:183], v[32:35], v[48:51]
  v_mfma_f32_16x16x32_bf16 v[48:51], v[184:187], v[36:39], v[48:51]
  v_cndmask_b32 v20, v44, v45, s[70:71]
  v_cndmask_b32 v21, v46, v47, s[70:71]
  s_nop 0
  v_add_f32_dpp v20, v20, v20 quad_perm:[2,3,0,1] row_mask:0xf bank_mask:0xf
  v_add_f32_dpp v21, v21, v21 quad_perm:[2,3,0,1] row_mask:0xf bank_mask:0xf
  v_cvt_pk_bf16_f32 v57, v20, v21
  v_lshlrev_b32 v10, 16, v57
  v_and_b32 v11, s67, v57
  v_mfma_f32_16x16x32_bf16 v[52:55], v[188:191], v[24:27], 0
  v_mfma_f32_16x16x32_bf16 v[52:55], v[192:195], v[28:31], v[52:55]
  v_mfma_f32_16x16x32_bf16 v[52:55], v[196:199], v[32:35], v[52:55]
  v_mfma_f32_16x16x32_bf16 v[52:55], v[200:203], v[36:39], v[52:55]
  s_waitcnt vmcnt(5)
  buffer_load_dwordx4 v[128:131], v1, s[8:11], s69 offen offset:128 nt
  v_cndmask_b32 v20, v48, v49, s[70:71]
  v_cndmask_b32 v21, v50, v51, s[70:71]
  s_nop 0
  v_add_f32_dpp v20, v20, v20 quad_perm:[2,3,0,1] row_mask:0xf bank_mask:0xf
  v_add_f32_dpp v21, v21, v21 quad_perm:[2,3,0,1] row_mask:0xf bank_mask:0xf
  v_cvt_pk_bf16_f32 v58, v20, v21
  v_lshlrev_b32 v12, 16, v58
  v_and_b32 v13, s67, v58
  v_cndmask_b32 v20, v52, v53, s[70:71]
  v_cndmask_b32 v21, v54, v55, s[70:71]
  s_nop 0
  v_add_f32_dpp v20, v20, v20 quad_perm:[2,3,0,1] row_mask:0xf bank_mask:0xf
  v_add_f32_dpp v21, v21, v21 quad_perm:[2,3,0,1] row_mask:0xf bank_mask:0xf
  v_cvt_pk_bf16_f32 v59, v20, v21
  v_lshlrev_b32 v14, 16, v59
  v_and_b32 v15, s67, v59
  ds_write_b128 v72, v[56:59]
  v_max3_f32 v16, v8, v9, v10
  v_max3_f32 v17, v11, v12, v13
  v_max3_f32 v16, v16, v14, v15
  v_max3_f32 v16, v16, v17, v4
  v_add_u32 v72, 1024, v72
  v_sub_f32 v17, v4, v16
  v_mul_f32 v7, s66, v16
  v_mul_f32 v17, s66, v17
  v_exp_f32 v6, v17
  v_mov_b32 v4, v16
  v_fma_f32 v8, v8, s66, -v7
  v_fma_f32 v9, v9, s66, -v7
  v_fma_f32 v10, v10, s66, -v7
  v_fma_f32 v11, v11, s66, -v7
  v_fma_f32 v12, v12, s66, -v7
  v_fma_f32 v13, v13, s66, -v7
  v_fma_f32 v14, v14, s66, -v7
  v_fma_f32 v15, v15, s66, -v7
  v_exp_f32 v8, v8
  v_exp_f32 v9, v9
  v_exp_f32 v10, v10
  v_exp_f32 v11, v11
  v_exp_f32 v12, v12
  v_exp_f32 v13, v13
  v_exp_f32 v14, v14
  v_exp_f32 v15, v15
  v_add_f32 v16, v8, v9
  v_add_f32 v17, v10, v11
  v_add_f32 v18, v12, v13
  v_add_f32 v19, v14, v15
  v_add_f32 v16, v16, v17
  v_add_f32 v18, v18, v19
  v_add_f32 v16, v16, v18
  v_fma_f32 v5, v5, v6, v16
  s_waitcnt vmcnt(5)
  buffer_load_dwordx4 v[132:135], v1, s[8:11], s69 offen offset:256 nt
  s_memrealtime s[54:55]
  v_mfma_f32_16x16x32_bf16 v[40:43], v[204:207], v[24:27], 0
  v_mfma_f32_16x16x32_bf16 v[40:43], v[208:211], v[28:31], v[40:43]
  v_mfma_f32_16x16x32_bf16 v[40:43], v[212:215], v[32:35], v[40:43]
  v_mfma_f32_16x16x32_bf16 v[40:43], v[216:219], v[36:39], v[40:43]
  v_mfma_f32_16x16x32_bf16 v[44:47], v[220:223], v[24:27], 0
  v_mfma_f32_16x16x32_bf16 v[44:47], v[224:227], v[28:31], v[44:47]
  v_mfma_f32_16x16x32_bf16 v[44:47], v[228:231], v[32:35], v[44:47]
  v_mfma_f32_16x16x32_bf16 v[44:47], v[232:235], v[36:39], v[44:47]
  s_nop 3
  v_cndmask_b32 v20, v40, v41, s[70:71]
  v_cndmask_b32 v21, v42, v43, s[70:71]
  s_nop 0
  v_add_f32_dpp v20, v20, v20 quad_perm:[2,3,0,1] row_mask:0xf bank_mask:0xf
  v_add_f32_dpp v21, v21, v21 quad_perm:[2,3,0,1] row_mask:0xf bank_mask:0xf
  v_cvt_pk_bf16_f32 v56, v20, v21
  v_lshlrev_b32 v8, 16, v56
  v_and_b32 v9, s67, v56
  s_waitcnt vmcnt(5)
  buffer_load_dwordx4 v[136:139], v1, s[8:11], s69 offen offset:384 nt
  s_cmp_lg_u32 s53, 0
  s_cbranch_scc1 L_first_nb
  s_waitcnt lgkmcnt(0)
  s_mov_b32 s56, s54
  s_mov_b32 s57, s76
  s_atomic_swap_x2 s[56:57], s[36:37], s59
L_first_nb:
  s_xor_b32 s45, s46, s47
  s_bfe_u32 s4, s45, 0x40000
  s_lshl_b32 s68, s4, 17
  s_or_b32 s68, s68, s44
  s_add_u32 s46, s46, 1
  s_add_u32 s69, s68, s48
  s_waitcnt vmcnt(5)
  buffer_load_dwordx4 v[140:143], v1, s[8:11], s69 offen offset:0 nt
  s_waitcnt vmcnt(5)
  buffer_load_dwordx4 v[144:147], v1, s[8:11], s69 offen offset:128 nt
  v_mfma_f32_16x16x32_bf16 v[48:51], v[108:111], v[24:27], 0
  v_mfma_f32_16x16x32_bf16 v[48:51], v[112:115], v[28:31], v[48:51]
  v_mfma_f32_16x16x32_bf16 v[48:51], v[116:119], v[32:35], v[48:51]
  v_mfma_f32_16x16x32_bf16 v[48:51], v[120:123], v[36:39], v[48:51]
  v_cndmask_b32 v20, v44, v45, s[70:71]
  v_cndmask_b32 v21, v46, v47, s[70:71]
  s_nop 0
  v_add_f32_dpp v20, v20, v20 quad_perm:[2,3,0,1] row_mask:0xf bank_mask:0xf
  v_add_f32_dpp v21, v21, v21 quad_perm:[2,3,0,1] row_mask:0xf bank_mask:0xf
  v_cvt_pk_bf16_f32 v57, v20, v21
  v_lshlrev_b32 v10, 16, v57
  v_and_b32 v11, s67, v57
  s_waitcnt vmcnt(5)
  buffer_load_dwordx4 v[148:151], v1, s[8:11], s69 offen offset:256 nt
  s_waitcnt vmcnt(5)
  buffer_load_dwordx4 v[152:155], v1, s[8:11], s69 offen offset:384 nt
  s_add_u32 s69, s68, s49
  s_waitcnt vmcnt(5)
  buffer_load_dwordx4 v[156:159], v1, s[8:11], s69 offen offset:0 nt
  s_waitcnt vmcnt(5)
  buffer_load_dwordx4 v[160:163], v1, s[8:11], s69 offen offset:128 nt
  v_mfma_f32_16x16x32_bf16 v[52:55], v[124:127], v[24:27], 0
  v_mfma_f32_16x16x32_bf16 v[52:55], v[128:131], v[28:31], v[52:55]
  v_mfma_f32_16x16x32_bf16 v[52:55], v[132:135], v[32:35], v[52:55]
  v_mfma_f32_16x16x32_bf16 v[52:55], v[136:139], v[36:39], v[52:55]
  v_cndmask_b32 v20, v48, v49, s[70:71]
  v_cndmask_b32 v21, v50, v51, s[70:71]
  s_nop 0
  v_add_f32_dpp v20, v20, v20 quad_perm:[2,3,0,1] row_mask:0xf bank_mask:0xf
  v_add_f32_dpp v21, v21, v21 quad_perm:[2,3,0,1] row_mask:0xf bank_mask:0xf
  v_cvt_pk_bf16_f32 v58, v20, v21
  v_lshlrev_b32 v12, 16, v58
  v_and_b32 v13, s67, v58
  s_waitcnt vmcnt(5)
  buffer_load_dwordx4 v[164:167], v1, s[8:11], s69 offen offset:256 nt
  s_waitcnt vmcnt(5)
  buffer_load_dwordx4 v[168:171], v1, s[8:11], s69 offen offset:384 nt
  s_add_u32 s69, s68, s50
  s_waitcnt vmcnt(5)
  buffer_load_dwordx4 v[172:175], v1, s[8:11], s69 offen offset:0 nt
  s_waitcnt vmcnt(5)
  buffer_load_dwordx4 v[176:179], v1, s[8:11], s69 offen offset:128 nt
  v_mfma_f32_16x16x32_bf16 v[40:43], v[140:143], v[24:27], 0
  v_mfma_f32_16x16x32_bf16 v[40:43], v[144:147], v[28:31], v[40:43]
  v_mfma_f32_16x16x32_bf16 v[40:43], v[148:151], v[32:35], v[40:43]
  v_mfma_f32_16x16x32_bf16 v[40:43], v[152:155], v[36:39], v[40:43]
  v_cndmask_b32 v20, v52, v53, s[70:71]
  v_cndmask_b32 v21, v54, v55, s[70:71]
  s_nop 0
  v_add_f32_dpp v20, v20, v20 quad_perm:[2,3,0,1] row_mask:0xf bank_mask:0xf
  v_add_f32_dpp v21, v21, v21 quad_perm:[2,3,0,1] row_mask:0xf bank_mask:0xf
  v_cvt_pk_bf16_f32 v59, v20, v21
  v_lshlrev_b32 v14, 16, v59
  v_and_b32 v15, s67, v59
  ds_write_b128 v72, v[56:59]
  v_max3_f32 v16, v8, v9, v10
  v_max3_f32 v17, v11, v12, v13
  v_max3_f32 v16, v16, v14, v15
  v_max3_f32 v16, v16, v17, v4
  v_add_u32 v72, 1024, v72
  v_sub_f32 v17, v4, v16
  v_mul_f32 v7, s66, v16
  v_mul_f32 v17, s66, v17
  v_exp_f32 v6, v17
  v_mov_b32 v4, v16
  v_fma_f32 v8, v8, s66, -v7
  v_fma_f32 v9, v9, s66, -v7
  v_fma_f32 v10, v10, s66, -v7
  v_fma_f32 v11, v11, s66, -v7
  v_fma_f32 v12, v12, s66, -v7
  v_fma_f32 v13, v13, s66, -v7
  v_fma_f32 v14, v14, s66, -v7
  v_fma_f32 v15, v15, s66, -v7
  v_exp_f32 v8, v8
  v_exp_f32 v9, v9
  v_exp_f32 v10, v10
  v_exp_f32 v11, v11
  v_exp_f32 v12, v12
  v_exp_f32 v13, v13
  v_exp_f32 v14, v14
  v_exp_f32 v15, v15
  v_add_f32 v16, v8, v9
  v_add_f32 v17, v10, v11
  v_add_f32 v18, v12, v13
  v_add_f32 v19, v14, v15
  v_add_f32 v16, v16, v17
  v_add_f32 v18, v18, v19
  v_add_f32 v16, v16, v18
  v_fma_f32 v5, v5, v6, v16
  s_waitcnt vmcnt(5)
  buffer_load_dwordx4 v[180:183], v1, s[8:11], s69 offen offset:256 nt
  v_cndmask_b32 v20, v40, v41, s[70:71]
  v_cndmask_b32 v21, v42, v43, s[70:71]
  s_nop 0
  v_add_f32_dpp v20, v20, v20 quad_perm:[2,3,0,1] row_mask:0xf bank_mask:0xf
  v_add_f32_dpp v21, v21, v21 quad_perm:[2,3,0,1] row_mask:0xf bank_mask:0xf
  v_cvt_pk_bf16_f32 v56, v20, v21
  v_lshlrev_b32 v8, 16, v56
  v_and_b32 v9, s67, v56
  s_waitcnt vmcnt(5)
  buffer_load_dwordx4 v[184:187], v1, s[8:11], s69 offen offset:384 nt
  s_add_u32 s69, s68, s51
  s_waitcnt vmcnt(5)
  buffer_load_dwordx4 v[188:191], v1, s[8:11], s69 offen offset:0 nt
  v_mfma_f32_16x16x32_bf16 v[44:47], v[156:159], v[24:27], 0
  v_mfma_f32_16x16x32_bf16 v[44:47], v[160:163], v[28:31], v[44:47]
  v_mfma_f32_16x16x32_bf16 v[44:47], v[164:167], v[32:35], v[44:47]
  s_waitcnt vmcnt(5)
  buffer_load_dwordx4 v[192:195], v1, s[8:11], s69 offen offset:128 nt
  s_load_dwordx16 s[16:31], s[36:37], 0
  s_waitcnt vmcnt(5)
  buffer_load_dwordx4 v[196:199], v1, s[8:11], s69 offen offset:256 nt
  s_waitcnt vmcnt(5)
  buffer_load_dwordx4 v[200:203], v1, s[8:11], s69 offen offset:384 nt
L_next:
  s_sub_u32 s72, s72, 1
  s_cmp_eq_u32 s72, 0
  s_cbranch_scc1 L_loopdone
  s_add_u32 s36, s36, 0x1100
  s_addc_u32 s37, s37, 0
  s_waitcnt lgkmcnt(0)
  s_mov_b32 s58, 1048576
  s_sub_i32 s16, s54, s16
  s_cmp_eq_u32 s17, s76
  s_cselect_b32 s4, s16, 1048576
  s_min_i32 s58, s58, s4
  s_sub_i32 s18, s54, s18
  s_cmp_eq_u32 s19, s76
  s_cselect_b32 s4, s18, 1048576
  s_min_i32 s58, s58, s4
  s_sub_i32 s20, s54, s20
  s_cmp_eq_u32 s21, s76
  s_cselect_b32 s4, s20, 1048576
  s_min_i32 s58, s58, s4
  s_sub_i32 s22, s54, s22
  s_cmp_eq_u32 s23, s76
  s_cselect_b32 s4, s22, 1048576
  s_min_i32 s58, s58, s4
  s_sub_i32 s24, s54, s24
  s_cmp_eq_u32 s25, s76
  s_cselect_b32 s4, s24, 1048576
  s_min_i32 s58, s58, s4
  s_sub_i32 s26, s54, s26
  s_cmp_eq_u32 s27, s76
  s_cselect_b32 s4, s26, 1048576
  s_min_i32 s58, s58, s4
  s_sub_i32 s28, s54, s28
  s_cmp_eq_u32 s29, s76
  s_cselect_b32 s4, s28, 1048576
  s_min_i32 s58, s58, s4
  s_sub_i32 s30, s54, s30
  s_cmp_eq_u32 s31, s76
  s_cselect_b32 s4, s30, 1048576
  s_min_i32 s58, s58, s4
  s_sub_i32 s5, s58, 100
  s_mov_b32 s6, 0
  s_cmp_eq_u32 s17, s76
  s_cselect_b32 s4, s16, s5
  s_add_i32 s6, s6, s4
  s_cmp_eq_u32 s19, s76
  s_cselect_b32 s4, s18, s5
  s_add_i32 s6, s6, s4
  s_cmp_eq_u32 s21, s76
  s_cselect_b32 s4, s20, s5
  s_add_i32 s6, s6, s4
  s_cmp_eq_u32 s23, s76
  s_cselect_b32 s4, s22, s5
  s_add_i32 s6, s6, s4
  s_cmp_eq_u32 s25, s76
  s_cselect_b32 s4, s24, s5
  s_add_i32 s6, s6, s4
  s_cmp_eq_u32 s27, s76
  s_cselect_b32 s4, s26, s5
  s_add_i32 s6, s6, s4
  s_cmp_eq_u32 s29, s76
  s_cselect_b32 s4, s28, s5
  s_add_i32 s6, s6, s4
  s_cmp_eq_u32 s31, s76
  s_cselect_b32 s4, s30, s5
  s_add_i32 s6, s6, s4
  s_ashr_i32 s6, s6, 3
  s_cmp_eq_u32 s58, 1048576
  s_cselect_b32 s6, 0, s6
  s_min_i32 s6, s6, 600
  s_max_i32 s6, s6, -600
  s_abs_i32 s4, s6
  s_abs_i32 s5, s77
  s_add_i32 s4, s4, 15
  s_cmp_ge_i32 s4, s5
  s_cselect_b32 s5, s6, 0
  s_cmp_ge_i32 s4, 135
  s_cselect_b32 s5, s5, 0
  s_ashr_i32 s7, s73, 1
  s_cmp_ge_i32 s4, 75
  s_cselect_b32 s7, 0, s7
  s_sub_i32 s73, s73, s7
  s_mov_b32 s77, s6
  s_mul_i32 s5, s5, 16
  s_add_i32 s73, s73, s5
  s_min_i32 s73, s73, 24576
  s_max_i32 s73, s73, -8192
  s_mov_b32 s5, 82
  s_cmp_le_u32 s72, 1
  s_cselect_b32 s5, 147, s5
  s_max_i32 s4, s6, 0
  s_mul_i32 s4, s4, s5
  s_add_i32 s5, s6, 10
  s_min_i32 s5, s5, 0
  s_mul_i32 s5, s5, 74
  s_add_i32 s4, s4, s5
  s_add_i32 s4, s4, s73
  s_add_i32 s4, s4, 46694
  s_ashr_i32 s4, s4, 12
  s_max_i32 s4, s4, 8
  s_min_i32 s4, s4, 18
  s_lshr_b32 s74, s4, 1
  s_add_u32 s75, s4, 1
  s_lshr_b32 s75, s75, 1
  s_cmp_lt_u32 s72, 8
  s_cbranch_scc1 L_vbody
  s_cmp_eq_u32 s72, 8
  s_cbranch_scc1 L_tbody
  s_xor_b32 s45, s46, s47
  s_bfe_u32 s4, s45, 0x40000
  s_lshl_b32 s68, s4, 17
  s_or_b32 s68, s68, s44
  s_add_u32 s46, s46, 1
  s_add_u32 s69, s68, s48
  s_waitcnt vmcnt(8)
  s_cmp_ge_u32 s74, 9
  s_cbranch_scc1 L_w727
  s_waitcnt vmcnt(7)
  s_cmp_ge_u32 s74, 8
  s_cbranch_scc1 L_w727
  s_waitcnt vmcnt(6)
  s_cmp_ge_u32 s74, 7
  s_cbranch_scc1 L_w727
  s_waitcnt vmcnt(5)
  s_cmp_ge_u32 s74, 6
  s_cbranch_scc1 L_w727
  s_waitcnt vmcnt(4)
  s_cmp_ge_u32 s74, 5
  s_cbranch_scc1 L_w727
  s_waitcnt vmcnt(3)
L_w727:
  buffer_load_dwordx4 v[76:79], v1, s[8:11], s69 offen offset:0 nt
  v_mfma_f32_16x16x32_bf16 v[44:47], v[168:171], v[36:39], v[44:47]
  s_waitcnt vmcnt(8)
  s_cmp_ge_u32 s75, 9
  s_cbranch_scc1 L_w746
  s_waitcnt vmcnt(7)
  s_cmp_ge_u32 s75, 8
  s_cbranch_scc1 L_w746
  s_waitcnt vmcnt(6)
  s_cmp_ge_u32 s75, 7
  s_cbranch_scc1 L_w746
  s_waitcnt vmcnt(5)
  s_cmp_ge_u32 s75, 6
  s_cbranch_scc1 L_w746
  s_waitcnt vmcnt(4)
  s_cmp_ge_u32 s75, 5
  s_cbranch_scc1 L_w746
  s_waitcnt vmcnt(3)
L_w746:
  buffer_load_dwordx4 v[80:83], v1, s[8:11], s69 offen offset:128 nt
  v_mfma_f32_16x16x32_bf16 v[48:51], v[172:175], v[24:27], 0
  s_waitcnt vmcnt(8)
  s_cmp_ge_u32 s74, 9
  s_cbranch_scc1 L_w765
  s_waitcnt vmcnt(7)
  s_cmp_ge_u32 s74, 8
  s_cbranch_scc1 L_w765
  s_waitcnt vmcnt(6)
  s_cmp_ge_u32 s74, 7
  s_cbranch_scc1 L_w765
  s_waitcnt vmcnt(5)
  s_cmp_ge_u32 s74, 6
  s_cbranch_scc1 L_w765
  s_waitcnt vmcnt(4)
  s_cmp_ge_u32 s74, 5
  s_cbranch_scc1 L_w765
  s_waitcnt vmcnt(3)
L_w765:
  buffer_load_dwordx4 v[84:87], v1, s[8:11], s69 offen offset:256 nt
  v_cndmask_b32 v20, v44, v45, s[70:71]
  v_cndmask_b32 v21, v46, v47, s[70:71]
  s_nop 0
  v_add_f32_dpp v20, v20, v20 quad_perm:[2,3,0,1] row_mask:0xf bank_mask:0xf
  v_add_f32_dpp v21, v21, v21 quad_perm:[2,3,0,1] row_mask:0xf bank_mask:0xf
  v_cvt_pk_bf16_f32 v57, v20, v21
  v_lshlrev_b32 v10, 16, v57
  v_and_b32 v11, s67, v57
  v_mfma_f32_16x16x32_bf16 v[48:51], v[176:179], v[28:31], v[48:51]
  s_waitcnt vmcnt(8)
  s_cmp_ge_u32 s75, 9
  s_cbranch_scc1 L_w792
  s_waitcnt vmcnt(7)
  s_cmp_ge_u32 s75, 8
  s_cbranch_scc1 L_w792
  s_waitcnt vmcnt(6)
  s_cmp_ge_u32 s75, 7
  s_cbranch_scc1 L_w792
  s_waitcnt vmcnt(5)
  s_cmp_ge_u32 s75, 6
  s_cbranch_scc1 L_w792
  s_waitcnt vmcnt(4)
  s_cmp_ge_u32 s75, 5
  s_cbranch_scc1 L_w792
  s_waitcnt vmcnt(3)
L_w792:
  buffer_load_dwordx4 v[88:91], v1, s[8:11], s69 offen offset:384 nt
  v_mfma_f32_16x16x32_bf16 v[48:51], v[180:183], v[32:35], v[48:51]
  s_add_u32 s69, s68, s49
  s_waitcnt vmcnt(8)
  s_cmp_ge_u32 s74, 9
  s_cbranch_scc1 L_w812
  s_waitcnt vmcnt(7)
  s_cmp_ge_u32 s74, 8
  s_cbranch_scc1 L_w812
  s_waitcnt vmcnt(6)
  s_cmp_ge_u32 s74, 7
  s_cbranch_scc1 L_w812
  s_waitcnt vmcnt(5)
  s_cmp_ge_u32 s74, 6
  s_cbranch_scc1 L_w812
  s_waitcnt vmcnt(4)
  s_cmp_ge_u32 s74, 5
  s_cbranch_scc1 L_w812
  s_waitcnt vmcnt(3)
L_w812:
  buffer_load_dwordx4 v[92:95], v1, s[8:11], s69 offen offset:0 nt
  v_mfma_f32_16x16x32_bf16 v[48:51], v[184:187], v[36:39], v[48:51]
  s_waitcnt vmcnt(8)
  s_cmp_ge_u32 s75, 9
  s_cbranch_scc1 L_w831
  s_waitcnt vmcnt(7)
  s_cmp_ge_u32 s75, 8
  s_cbranch_scc1 L_w831
  s_waitcnt vmcnt(6)
  s_cmp_ge_u32 s75, 7
  s_cbranch_scc1 L_w831
  s_waitcnt vmcnt(5)
  s_cmp_ge_u32 s75, 6
  s_cbranch_scc1 L_w831
  s_waitcnt vmcnt(4)
  s_cmp_ge_u32 s75, 5
  s_cbranch_scc1 L_w831
  s_waitcnt vmcnt(3)
L_w831:
  buffer_load_dwordx4 v[96:99], v1, s[8:11], s69 offen offset:128 nt
  v_mfma_f32_16x16x32_bf16 v[52:55], v[188:191], v[24:27], 0
  s_waitcnt vmcnt(8)
  s_cmp_ge_u32 s74, 9
  s_cbranch_scc1 L_w850
  s_waitcnt vmcnt(7)
  s_cmp_ge_u32 s74, 8
  s_cbranch_scc1 L_w850
  s_waitcnt vmcnt(6)
  s_cmp_ge_u32 s74, 7
  s_cbranch_scc1 L_w850
  s_waitcnt vmcnt(5)
  s_cmp_ge_u32 s74, 6
  s_cbranch_scc1 L_w850
  s_waitcnt vmcnt(4)
  s_cmp_ge_u32 s74, 5
  s_cbranch_scc1 L_w850
  s_waitcnt vmcnt(3)
L_w850:
  buffer_load_dwordx4 v[100:103], v1, s[8:11], s69 offen offset:256 nt
  v_cndmask_b32 v20, v48, v49, s[70:71]
  v_cndmask_b32 v21, v50, v51, s[70:71]
  s_nop 0
  v_add_f32_dpp v20, v20, v20 quad_perm:[2,3,0,1] row_mask:0xf bank_mask:0xf
  v_add_f32_dpp v21, v21, v21 quad_perm:[2,3,0,1] row_mask:0xf bank_mask:0xf
  v_cvt_pk_bf16_f32 v58, v20, v21
  v_lshlrev_b32 v12, 16, v58
  v_and_b32 v13, s67, v58
  v_mfma_f32_16x16x32_bf16 v[52:55], v[192:195], v[28:31], v[52:55]
  s_waitcnt vmcnt(8)
  s_cmp_ge_u32 s75, 9
  s_cbranch_scc1 L_w877
  s_waitcnt vmcnt(7)
  s_cmp_ge_u32 s75, 8
  s_cbranch_scc1 L_w877
  s_waitcnt vmcnt(6)
  s_cmp_ge_u32 s75, 7
  s_cbranch_scc1 L_w877
  s_waitcnt vmcnt(5)
  s_cmp_ge_u32 s75, 6
  s_cbranch_scc1 L_w877
  s_waitcnt vmcnt(4)
  s_cmp_ge_u32 s75, 5
  s_cbranch_scc1 L_w877
  s_waitcnt vmcnt(3)
L_w877:
  buffer_load_dwordx4 v[104:107], v1, s[8:11], s69 offen offset:384 nt
  v_mfma_f32_16x16x32_bf16 v[52:55], v[196:199], v[32:35], v[52:55]
  s_add_u32 s69, s68, s50
  s_waitcnt vmcnt(8)
  s_cmp_ge_u32 s74, 9
  s_cbranch_scc1 L_w897
  s_waitcnt vmcnt(7)
  s_cmp_ge_u32 s74, 8
  s_cbranch_scc1 L_w897
  s_waitcnt vmcnt(6)
  s_cmp_ge_u32 s74, 7
  s_cbranch_scc1 L_w897
  s_waitcnt vmcnt(5)
  s_cmp_ge_u32 s74, 6
  s_cbranch_scc1 L_w897
  s_waitcnt vmcnt(4)
  s_cmp_ge_u32 s74, 5
  s_cbranch_scc1 L_w897
  s_waitcnt vmcnt(3)
L_w897:
  buffer_load_dwordx4 v[108:111], v1, s[8:11], s69 offen offset:0 nt
  v_mfma_f32_16x16x32_bf16 v[52:55], v[200:203], v[36:39], v[52:55]
  s_waitcnt vmcnt(8)
  s_cmp_ge_u32 s75, 9
  s_cbranch_scc1 L_w916
  s_waitcnt vmcnt(7)
  s_cmp_ge_u32 s75, 8
  s_cbranch_scc1 L_w916
  s_waitcnt vmcnt(6)
  s_cmp_ge_u32 s75, 7
  s_cbranch_scc1 L_w916
  s_waitcnt vmcnt(5)
  s_cmp_ge_u32 s75, 6
  s_cbranch_scc1 L_w916
  s_waitcnt vmcnt(4)
  s_cmp_ge_u32 s75, 5
  s_cbranch_scc1 L_w916
  s_waitcnt vmcnt(3)
L_w916:
  buffer_load_dwordx4 v[112:115], v1, s[8:11], s69 offen offset:128 nt
  v_mfma_f32_16x16x32_bf16 v[40:43], v[76:79], v[24:27], 0
  s_waitcnt vmcnt(8)
  s_cmp_ge_u32 s74, 9
  s_cbranch_scc1 L_w935
  s_waitcnt vmcnt(7)
  s_cmp_ge_u32 s74, 8
  s_cbranch_scc1 L_w935
  s_waitcnt vmcnt(6)
  s_cmp_ge_u32 s74, 7
  s_cbranch_scc1 L_w935
  s_waitcnt vmcnt(5)
  s_cmp_ge_u32 s74, 6
  s_cbranch_scc1 L_w935
  s_waitcnt vmcnt(4)
  s_cmp_ge_u32 s74, 5
  s_cbranch_scc1 L_w935
  s_waitcnt vmcnt(3)
L_w935:
  buffer_load_dwordx4 v[116:119], v1, s[8:11], s69 offen offset:256 nt
  v_cndmask_b32 v20, v52, v53, s[70:71]
  v_cndmask_b32 v21, v54, v55, s[70:71]
  s_nop 0
  v_add_f32_dpp v20, v20, v20 quad_perm:[2,3,0,1] row_mask:0xf bank_mask:0xf
  v_add_f32_dpp v21, v21, v21 quad_perm:[2,3,0,1] row_mask:0xf bank_mask:0xf
  v_cvt_pk_bf16_f32 v59, v20, v21
  v_lshlrev_b32 v14, 16, v59
  v_and_b32 v15, s67, v59
  ds_write_b128 v72, v[56:59]
  v_max3_f32 v16, v8, v9, v10
  v_max3_f32 v17, v11, v12, v13
  v_max3_f32 v16, v16, v14, v15
  v_max3_f32 v16, v16, v17, v4
  v_add_u32 v72, 1024, v72
  v_sub_f32 v17, v4, v16
  v_mul_f32 v7, s66, v16
  v_mul_f32 v17, s66, v17
  v_exp_f32 v6, v17
  v_mov_b32 v4, v16
  v_mfma_f32_16x16x32_bf16 v[40:43], v[80:83], v[28:31], v[40:43]
  s_waitcnt vmcnt(8)
  s_cmp_ge_u32 s75, 9
  s_cbranch_scc1 L_w973
  s_waitcnt vmcnt(7)
  s_cmp_ge_u32 s75, 8
  s_cbranch_scc1 L_w973
  s_waitcnt vmcnt(6)
  s_cmp_ge_u32 s75, 7
  s_cbranch_scc1 L_w973
  s_waitcnt vmcnt(5)
  s_cmp_ge_u32 s75, 6
  s_cbranch_scc1 L_w973
  s_waitcnt vmcnt(4)
  s_cmp_ge_u32 s75, 5
  s_cbranch_scc1 L_w973
  s_waitcnt vmcnt(3)
L_w973:
  buffer_load_dwordx4 v[120:123], v1, s[8:11], s69 offen offset:384 nt
  v_fma_f32 v8, v8, s66, -v7
  v_fma_f32 v9, v9, s66, -v7
  v_fma_f32 v10, v10, s66, -v7
  v_fma_f32 v11, v11, s66, -v7
  v_fma_f32 v12, v12, s66, -v7
  v_fma_f32 v13, v13, s66, -v7
  v_fma_f32 v14, v14, s66, -v7
  v_fma_f32 v15, v15, s66, -v7
  v_exp_f32 v8, v8
  v_exp_f32 v9, v9
  v_exp_f32 v10, v10
  v_exp_f32 v11, v11
  v_mfma_f32_16x16x32_bf16 v[40:43], v[84:87], v[32:35], v[40:43]
  s_add_u32 s69, s68, s51
  s_waitcnt vmcnt(8)
  s_cmp_ge_u32 s74, 9
  s_cbranch_scc1 L_w1005
  s_waitcnt vmcnt(7)
  s_cmp_ge_u32 s74, 8
  s_cbranch_scc1 L_w1005
  s_waitcnt vmcnt(6)
  s_cmp_ge_u32 s74, 7
  s_cbranch_scc1 L_w1005
  s_waitcnt vmcnt(5)
  s_cmp_ge_u32 s74, 6
  s_cbranch_scc1 L_w1005
  s_waitcnt vmcnt(4)
  s_cmp_ge_u32 s74, 5
  s_cbranch_scc1 L_w1005
  s_waitcnt vmcnt(3)
L_w1005:
  buffer_load_dwordx4 v[124:127], v1, s[8:11], s69 offen offset:0 nt
  v_exp_f32 v12, v12
  v_exp_f32 v13, v13
  v_exp_f32 v14, v14
  v_exp_f32 v15, v15
  v_add_f32 v16, v8, v9
  v_add_f32 v17, v10, v11
  v_add_f32 v18, v12, v13
  v_add_f32 v19, v14, v15
  v_add_f32 v16, v16, v17
  v_add_f32 v18, v18, v19
  v_add_f32 v16, v16, v18
  v_fma_f32 v5, v5, v6, v16
  v_mfma_f32_16x16x32_bf16 v[40:43], v[88:91], v[36:39], v[40:43]
  s_waitcnt vmcnt(8)
  s_cmp_ge_u32 s75, 9
  s_cbranch_scc1 L_w1036
  s_waitcnt vmcnt(7)
  s_cmp_ge_u32 s75, 8
  s_cbranch_scc1 L_w1036
  s_waitcnt vmcnt(6)
  s_cmp_ge_u32 s75, 7
  s_cbranch_scc1 L_w1036
  s_waitcnt vmcnt(5)
  s_cmp_ge_u32 s75, 6
  s_cbranch_scc1 L_w1036
  s_waitcnt vmcnt(4)
  s_cmp_ge_u32 s75, 5
  s_cbranch_scc1 L_w1036
  s_waitcnt vmcnt(3)
L_w1036:
  buffer_load_dwordx4 v[128:131], v1, s[8:11], s69 offen offset:128 nt
  v_mfma_f32_16x16x32_bf16 v[44:47], v[92:95], v[24:27], 0
  s_waitcnt vmcnt(8)
  s_cmp_ge_u32 s74, 9
  s_cbranch_scc1 L_w1055
  s_waitcnt vmcnt(7)
  s_cmp_ge_u32 s74, 8
  s_cbranch_scc1 L_w1055
  s_waitcnt vmcnt(6)
  s_cmp_ge_u32 s74, 7
  s_cbranch_scc1 L_w1055
  s_waitcnt vmcnt(5)
  s_cmp_ge_u32 s74, 6
  s_cbranch_scc1 L_w1055
  s_waitcnt vmcnt(4)
  s_cmp_ge_u32 s74, 5
  s_cbranch_scc1 L_w1055
  s_waitcnt vmcnt(3)
L_w1055:
  buffer_load_dwordx4 v[132:135], v1, s[8:11], s69 offen offset:256 nt
  s_memrealtime s[54:55]
  v_cndmask_b32 v20, v40, v41, s[70:71]
  v_cndmask_b32 v21, v42, v43, s[70:71]
  s_nop 0
  v_add_f32_dpp v20, v20, v20 quad_perm:[2,3,0,1] row_mask:0xf bank_mask:0xf
  v_add_f32_dpp v21, v21, v21 quad_perm:[2,3,0,1] row_mask:0xf bank_mask:0xf
  v_cvt_pk_bf16_f32 v56, v20, v21
  v_lshlrev_b32 v8, 16, v56
  v_and_b32 v9, s67, v56
  v_mfma_f32_16x16x32_bf16 v[44:47], v[96:99], v[28:31], v[44:47]
  s_waitcnt vmcnt(8)
  s_cmp_ge_u32 s75, 9
  s_cbranch_scc1 L_w1083
  s_waitcnt vmcnt(7)
  s_cmp_ge_u32 s75, 8
  s_cbranch_scc1 L_w1083
  s_waitcnt vmcnt(6)
  s_cmp_ge_u32 s75, 7
  s_cbranch_scc1 L_w1083
  s_waitcnt vmcnt(5)
  s_cmp_ge_u32 s75, 6
  s_cbranch_scc1 L_w1083
  s_waitcnt vmcnt(4)
  s_cmp_ge_u32 s75, 5
  s_cbranch_scc1 L_w1083
  s_waitcnt vmcnt(3)
L_w1083:
  buffer_load_dwordx4 v[136:139], v1, s[8:11], s69 offen offset:384 nt
  s_cmp_lg_u32 s53, 0
  s_cbranch_scc1 L_kb_nb
  s_waitcnt lgkmcnt(0)
  s_mov_b32 s56, s54
  s_mov_b32 s57, s76
  s_atomic_swap_x2 s[56:57], s[36:37], s59
L_kb_nb:
  v_mfma_f32_16x16x32_bf16 v[44:47], v[100:103], v[32:35], v[44:47]
  s_xor_b32 s45, s46, s47
  s_bfe_u32 s4, s45, 0x40000
  s_lshl_b32 s68, s4, 17
  s_or_b32 s68, s68, s44
  s_add_u32 s46, s46, 1
  s_add_u32 s69, s68, s48
  s_waitcnt vmcnt(8)
  s_cmp_ge_u32 s74, 9
  s_cbranch_scc1 L_w1115
  s_waitcnt vmcnt(7)
  s_cmp_ge_u32 s74, 8
  s_cbranch_scc1 L_w1115
  s_waitcnt vmcnt(6)
  s_cmp_ge_u32 s74, 7
  s_cbranch_scc1 L_w1115
  s_waitcnt vmcnt(5)
  s_cmp_ge_u32 s74, 6
  s_cbranch_scc1 L_w1115
  s_waitcnt vmcnt(4)
  s_cmp_ge_u32 s74, 5
  s_cbranch_scc1 L_w1115
  s_waitcnt vmcnt(3)
L_w1115:
  buffer_load_dwordx4 v[140:143], v1, s[8:11], s69 offen offset:0 nt
  v_mfma_f32_16x16x32_bf16 v[44:47], v[104:107], v[36:39], v[44:47]
  s_waitcnt vmcnt(8)
  s_cmp_ge_u32 s75, 9
  s_cbranch_scc1 L_w1134
  s_waitcnt vmcnt(7)
  s_cmp_ge_u32 s75, 8
  s_cbranch_scc1 L_w1134
  s_waitcnt vmcnt(6)
  s_cmp_ge_u32 s75, 7
  s_cbranch_scc1 L_w1134
  s_waitcnt vmcnt(5)
  s_cmp_ge_u32 s75, 6
  s_cbranch_scc1 L_w1134
  s_waitcnt vmcnt(4)
  s_cmp_ge_u32 s75, 5
  s_cbranch_scc1 L_w1134
  s_waitcnt vmcnt(3)
L_w1134:
  buffer_load_dwordx4 v[144:147], v1, s[8:11], s69 offen offset:128 nt
  v_mfma_f32_16x16x32_bf16 v[48:51], v[108:111], v[24:27], 0
  s_waitcnt vmcnt(8)
  s_cmp_ge_u32 s74, 9
  s_cbranch_scc1 L_w1153
  s_waitcnt vmcnt(7)
  s_cmp_ge_u32 s74, 8
  s_cbranch_scc1 L_w1153
  s_waitcnt vmcnt(6)
  s_cmp_ge_u32 s74, 7
  s_cbranch_scc1 L_w1153
  s_waitcnt vmcnt(5)
  s_cmp_ge_u32 s74, 6
  s_cbranch_scc1 L_w1153
  s_waitcnt vmcnt(4)
  s_cmp_ge_u32 s74, 5
  s_cbranch_scc1 L_w1153
  s_waitcnt vmcnt(3)
L_w1153:
  buffer_load_dwordx4 v[148:151], v1, s[8:11], s69 offen offset:256 nt
  v_cndmask_b32 v20, v44, v45, s[70:71]
  v_cndmask_b32 v21, v46, v47, s[70:71]
  s_nop 0
  v_add_f32_dpp v20, v20, v20 quad_perm:[2,3,0,1] row_mask:0xf bank_mask:0xf
  v_add_f32_dpp v21, v21, v21 quad_perm:[2,3,0,1] row_mask:0xf bank_mask:0xf
  v_cvt_pk_bf16_f32 v57, v20, v21
  v_lshlrev_b32 v10, 16, v57
  v_and_b32 v11, s67, v57
  v_mfma_f32_16x16x32_bf16 v[48:51], v[112:115], v[28:31], v[48:51]
  s_waitcnt vmcnt(8)
  s_cmp_ge_u32 s75, 9
  s_cbranch_scc1 L_w1180
  s_waitcnt vmcnt(7)
  s_cmp_ge_u32 s75, 8
  s_cbranch_scc1 L_w1180
  s_waitcnt vmcnt(6)
  s_cmp_ge_u32 s75, 7
  s_cbranch_scc1 L_w1180
  s_waitcnt vmcnt(5)
  s_cmp_ge_u32 s75, 6
  s_cbranch_scc1 L_w1180
  s_waitcnt vmcnt(4)
  s_cmp_ge_u32 s75, 5
  s_cbranch_scc1 L_w1180
  s_waitcnt vmcnt(3)
L_w1180:
  buffer_load_dwordx4 v[152:155], v1, s[8:11], s69 offen offset:384 nt
  v_mfma_f32_16x16x32_bf16 v[48:51], v[116:119], v[32:35], v[48:51]
  s_add_u32 s69, s68, s49
  s_waitcnt vmcnt(8)
  s_cmp_ge_u32 s74, 9
  s_cbranch_scc1 L_w1200
  s_waitcnt vmcnt(7)
  s_cmp_ge_u32 s74, 8
  s_cbranch_scc1 L_w1200
  s_waitcnt vmcnt(6)
  s_cmp_ge_u32 s74, 7
  s_cbranch_scc1 L_w1200
  s_waitcnt vmcnt(5)
  s_cmp_ge_u32 s74, 6
  s_cbranch_scc1 L_w1200
  s_waitcnt vmcnt(4)
  s_cmp_ge_u32 s74, 5
  s_cbranch_scc1 L_w1200
  s_waitcnt vmcnt(3)
L_w1200:
  buffer_load_dwordx4 v[156:159], v1, s[8:11], s69 offen offset:0 nt
  v_mfma_f32_16x16x32_bf16 v[48:51], v[120:123], v[36:39], v[48:51]
  s_waitcnt vmcnt(8)
  s_cmp_ge_u32 s75, 9
  s_cbranch_scc1 L_w1219
  s_waitcnt vmcnt(7)
  s_cmp_ge_u32 s75, 8
  s_cbranch_scc1 L_w1219
  s_waitcnt vmcnt(6)
  s_cmp_ge_u32 s75, 7
  s_cbranch_scc1 L_w1219
  s_waitcnt vmcnt(5)
  s_cmp_ge_u32 s75, 6
  s_cbranch_scc1 L_w1219
  s_waitcnt vmcnt(4)
  s_cmp_ge_u32 s75, 5
  s_cbranch_scc1 L_w1219
  s_waitcnt vmcnt(3)
L_w1219:
  buffer_load_dwordx4 v[160:163], v1, s[8:11], s69 offen offset:128 nt
  v_mfma_f32_16x16x32_bf16 v[52:55], v[124:127], v[24:27], 0
  s_waitcnt vmcnt(8)
  s_cmp_ge_u32 s74, 9
  s_cbranch_scc1 L_w1238
  s_waitcnt vmcnt(7)
  s_cmp_ge_u32 s74, 8
  s_cbranch_scc1 L_w1238
  s_waitcnt vmcnt(6)
  s_cmp_ge_u32 s74, 7
  s_cbranch_scc1 L_w1238
  s_waitcnt vmcnt(5)
  s_cmp_ge_u32 s74, 6
  s_cbranch_scc1 L_w1238
  s_waitcnt vmcnt(4)
  s_cmp_ge_u32 s74, 5
  s_cbranch_scc1 L_w1238
  s_waitcnt vmcnt(3)
L_w1238:
  buffer_load_dwordx4 v[164:167], v1, s[8:11], s69 offen offset:256 nt
  v_cndmask_b32 v20, v48, v49, s[70:71]
  v_cndmask_b32 v21, v50, v51, s[70:71]
  s_nop 0
  v_add_f32_dpp v20, v20, v20 quad_perm:[2,3,0,1] row_mask:0xf bank_mask:0xf
  v_add_f32_dpp v21, v21, v21 quad_perm:[2,3,0,1] row_mask:0xf bank_mask:0xf
  v_cvt_pk_bf16_f32 v58, v20, v21
  v_lshlrev_b32 v12, 16, v58
  v_and_b32 v13, s67, v58
  v_mfma_f32_16x16x32_bf16 v[52:55], v[128:131], v[28:31], v[52:55]
  s_waitcnt vmcnt(8)
  s_cmp_ge_u32 s75, 9
  s_cbranch_scc1 L_w1265
  s_waitcnt vmcnt(7)
  s_cmp_ge_u32 s75, 8
  s_cbranch_scc1 L_w1265
  s_waitcnt vmcnt(6)
  s_cmp_ge_u32 s75, 7
  s_cbranch_scc1 L_w1265
  s_waitcnt vmcnt(5)
  s_cmp_ge_u32 s75, 6
  s_cbranch_scc1 L_w1265
  s_waitcnt vmcnt(4)
  s_cmp_ge_u32 s75, 5
  s_cbranch_scc1 L_w1265
  s_waitcnt vmcnt(3)
L_w1265:
  buffer_load_dwordx4 v[168:171], v1, s[8:11], s69 offen offset:384 nt
  v_mfma_f32_16x16x32_bf16 v[52:55], v[132:135], v[32:35], v[52:55]
  s_add_u32 s69, s68, s50
  s_waitcnt vmcnt(8)
  s_cmp_ge_u32 s74, 9
  s_cbranch_scc1 L_w1285
  s_waitcnt vmcnt(7)
  s_cmp_ge_u32 s74, 8
  s_cbranch_scc1 L_w1285
  s_waitcnt vmcnt(6)
  s_cmp_ge_u32 s74, 7
  s_cbranch_scc1 L_w1285
  s_waitcnt vmcnt(5)
  s_cmp_ge_u32 s74, 6
  s_cbranch_scc1 L_w1285
  s_waitcnt vmcnt(4)
  s_cmp_ge_u32 s74, 5
  s_cbranch_scc1 L_w1285
  s_waitcnt vmcnt(3)
L_w1285:
  buffer_load_dwordx4 v[172:175], v1, s[8:11], s69 offen offset:0 nt
  v_mfma_f32_16x16x32_bf16 v[52:55], v[136:139], v[36:39], v[52:55]
  s_waitcnt vmcnt(8)
  s_cmp_ge_u32 s75, 9
  s_cbranch_scc1 L_w1304
  s_waitcnt vmcnt(7)
  s_cmp_ge_u32 s75, 8
  s_cbranch_scc1 L_w1304
  s_waitcnt vmcnt(6)
  s_cmp_ge_u32 s75, 7
  s_cbranch_scc1 L_w1304
  s_waitcnt vmcnt(5)
  s_cmp_ge_u32 s75, 6
  s_cbranch_scc1 L_w1304
  s_waitcnt vmcnt(4)
  s_cmp_ge_u32 s75, 5
  s_cbranch_scc1 L_w1304
  s_waitcnt vmcnt(3)
L_w1304:
  buffer_load_dwordx4 v[176:179], v1, s[8:11], s69 offen offset:128 nt
  v_mfma_f32_16x16x32_bf16 v[40:43], v[140:143], v[24:27], 0
  s_waitcnt vmcnt(8)
  s_cmp_ge_u32 s74, 9
  s_cbranch_scc1 L_w1323
  s_waitcnt vmcnt(7)
  s_cmp_ge_u32 s74, 8
  s_cbranch_scc1 L_w1323
  s_waitcnt vmcnt(6)
  s_cmp_ge_u32 s74, 7
  s_cbranch_scc1 L_w1323
  s_waitcnt vmcnt(5)
  s_cmp_ge_u32 s74, 6
  s_cbranch_scc1 L_w1323
  s_waitcnt vmcnt(4)
  s_cmp_ge_u32 s74, 5
  s_cbranch_scc1 L_w1323
  s_waitcnt vmcnt(3)
L_w1323:
  buffer_load_dwordx4 v[180:183], v1, s[8:11], s69 offen offset:256 nt
  v_cndmask_b32 v20, v52, v53, s[70:71]
  v_cndmask_b32 v21, v54, v55, s[70:71]
  s_nop 0
  v_add_f32_dpp v20, v20, v20 quad_perm:[2,3,0,1] row_mask:0xf bank_mask:0xf
  v_add_f32_dpp v21, v21, v21 quad_perm:[2,3,0,1] row_mask:0xf bank_mask:0xf
  v_cvt_pk_bf16_f32 v59, v20, v21
  v_lshlrev_b32 v14, 16, v59
  v_and_b32 v15, s67, v59
  ds_write_b128 v72, v[56:59]
  v_max3_f32 v16, v8, v9, v10
  v_max3_f32 v17, v11, v12, v13
  v_max3_f32 v16, v16, v14, v15
  v_max3_f32 v16, v16, v17, v4
  v_add_u32 v72, 1024, v72
  v_sub_f32 v17, v4, v16
  v_mul_f32 v7, s66, v16
  v_mul_f32 v17, s66, v17
  v_exp_f32 v6, v17
  v_mov_b32 v4, v16
  v_mfma_f32_16x16x32_bf16 v[40:43], v[144:147], v[28:31], v[40:43]
  s_waitcnt vmcnt(8)
  s_cmp_ge_u32 s75, 9
  s_cbranch_scc1 L_w1361
  s_waitcnt vmcnt(7)
  s_cmp_ge_u32 s75, 8
  s_cbranch_scc1 L_w1361
  s_waitcnt vmcnt(6)
  s_cmp_ge_u32 s75, 7
  s_cbranch_scc1 L_w1361
  s_waitcnt vmcnt(5)
  s_cmp_ge_u32 s75, 6
  s_cbranch_scc1 L_w1361
  s_waitcnt vmcnt(4)
  s_cmp_ge_u32 s75, 5
  s_cbranch_scc1 L_w1361
  s_waitcnt vmcnt(3)
L_w1361:
  buffer_load_dwordx4 v[184:187], v1, s[8:11], s69 offen offset:384 nt
  v_fma_f32 v8, v8, s66, -v7
  v_fma_f32 v9, v9, s66, -v7
  v_fma_f32 v10, v10, s66, -v7
  v_fma_f32 v11, v11, s66, -v7
  v_fma_f32 v12, v12, s66, -v7
  v_fma_f32 v13, v13, s66, -v7
  v_fma_f32 v14, v14, s66, -v7
  v_fma_f32 v15, v15, s66, -v7
  v_exp_f32 v8, v8
  v_exp_f32 v9, v9
  v_exp_f32 v10, v10
  v_exp_f32 v11, v11
  v_mfma_f32_16x16x32_bf16 v[40:43], v[148:151], v[32:35], v[40:43]
  s_add_u32 s69, s68, s51
  s_waitcnt vmcnt(8)
  s_cmp_ge_u32 s74, 9
  s_cbranch_scc1 L_w1393
  s_waitcnt vmcnt(7)
  s_cmp_ge_u32 s74, 8
  s_cbranch_scc1 L_w1393
  s_waitcnt vmcnt(6)
  s_cmp_ge_u32 s74, 7
  s_cbranch_scc1 L_w1393
  s_waitcnt vmcnt(5)
  s_cmp_ge_u32 s74, 6
  s_cbranch_scc1 L_w1393
  s_waitcnt vmcnt(4)
  s_cmp_ge_u32 s74, 5
  s_cbranch_scc1 L_w1393
  s_waitcnt vmcnt(3)
L_w1393:
  buffer_load_dwordx4 v[188:191], v1, s[8:11], s69 offen offset:0 nt
  v_exp_f32 v12, v12
  v_exp_f32 v13, v13
  v_exp_f32 v14, v14
  v_exp_f32 v15, v15
  v_add_f32 v16, v8, v9
  v_add_f32 v17, v10, v11
  v_add_f32 v18, v12, v13
  v_add_f32 v19, v14, v15
  v_add_f32 v16, v16, v17
  v_add_f32 v18, v18, v19
  v_add_f32 v16, v16, v18
  v_fma_f32 v5, v5, v6, v16
  v_mfma_f32_16x16x32_bf16 v[40:43], v[152:155], v[36:39], v[40:43]
  s_waitcnt vmcnt(8)
  s_cmp_ge_u32 s75, 9
  s_cbranch_scc1 L_w1424
  s_waitcnt vmcnt(7)
  s_cmp_ge_u32 s75, 8
  s_cbranch_scc1 L_w1424
  s_waitcnt vmcnt(6)
  s_cmp_ge_u32 s75, 7
  s_cbranch_scc1 L_w1424
  s_waitcnt vmcnt(5)
  s_cmp_ge_u32 s75, 6
  s_cbranch_scc1 L_w1424
  s_waitcnt vmcnt(4)
  s_cmp_ge_u32 s75, 5
  s_cbranch_scc1 L_w1424
  s_waitcnt vmcnt(3)
L_w1424:
  buffer_load_dwordx4 v[192:195], v1, s[8:11], s69 offen offset:128 nt
  s_load_dwordx16 s[16:31], s[36:37], 0
  v_mfma_f32_16x16x32_bf16 v[44:47], v[156:159], v[24:27], 0
  s_waitcnt vmcnt(8)
  s_cmp_ge_u32 s74, 9
  s_cbranch_scc1 L_w1444
  s_waitcnt vmcnt(7)
  s_cmp_ge_u32 s74, 8
  s_cbranch_scc1 L_w1444
  s_waitcnt vmcnt(6)
  s_cmp_ge_u32 s74, 7
  s_cbranch_scc1 L_w1444
  s_waitcnt vmcnt(5)
  s_cmp_ge_u32 s74, 6
  s_cbranch_scc1 L_w1444
  s_waitcnt vmcnt(4)
  s_cmp_ge_u32 s74, 5
  s_cbranch_scc1 L_w1444
  s_waitcnt vmcnt(3)
L_w1444:
  buffer_load_dwordx4 v[196:199], v1, s[8:11], s69 offen offset:256 nt
  v_cndmask_b32 v20, v40, v41, s[70:71]
  v_cndmask_b32 v21, v42, v43, s[70:71]
  s_nop 0
  v_add_f32_dpp v20, v20, v20 quad_perm:[2,3,0,1] row_mask:0xf bank_mask:0xf
  v_add_f32_dpp v21, v21, v21 quad_perm:[2,3,0,1] row_mask:0xf bank_mask:0xf
  v_cvt_pk_bf16_f32 v56, v20, v21
  v_lshlrev_b32 v8, 16, v56
  v_and_b32 v9, s67, v56
  v_mfma_f32_16x16x32_bf16 v[44:47], v[160:163], v[28:31], v[44:47]
  s_waitcnt vmcnt(8)
  s_cmp_ge_u32 s75, 9
  s_cbranch_scc1 L_w1471
  s_waitcnt vmcnt(7)
  s_cmp_ge_u32 s75, 8
  s_cbranch_scc1 L_w1471
  s_waitcnt vmcnt(6)
  s_cmp_ge_u32 s75, 7
  s_cbranch_scc1 L_w1471
  s_waitcnt vmcnt(5)
  s_cmp_ge_u32 s75, 6
  s_cbranch_scc1 L_w1471
  s_waitcnt vmcnt(4)
  s_cmp_ge_u32 s75, 5
  s_cbranch_scc1 L_w1471
  s_waitcnt vmcnt(3)
L_w1471:
  buffer_load_dwordx4 v[200:203], v1, s[8:11], s69 offen offset:384 nt
  v_mfma_f32_16x16x32_bf16 v[44:47], v[164:167], v[32:35], v[44:47]
  s_branch L_next
L_tbody:
  s_add_u32 s74, s74, 1
  s_add_u32 s75, s75, 1
  s_xor_b32 s45, s46, s47
  s_bfe_u32 s4, s45, 0x40000
  s_lshl_b32 s68, s4, 17
  s_or_b32 s68, s68, s44
  s_add_u32 s46, s46, 1
  s_add_u32 s69, s68, s48
  s_waitcnt vmcnt(8)
  s_cmp_ge_u32 s74, 9
  s_cbranch_scc1 L_w1501
  s_waitcnt vmcnt(7)
  s_cmp_ge_u32 s74, 8
  s_cbranch_scc1 L_w1501
  s_waitcnt vmcnt(6)
  s_cmp_ge_u32 s74, 7
  s_cbranch_scc1 L_w1501
  s_waitcnt vmcnt(5)
  s_cmp_ge_u32 s74, 6
  s_cbranch_scc1 L_w1501
  s_waitcnt vmcnt(4)
  s_cmp_ge_u32 s74, 5
  s_cbranch_scc1 L_w1501
  s_waitcnt vmcnt(3)
L_w1501:
  buffer_load_dwordx4 v[76:79], v2, s[12:15], s69 offen offset:0 nt
  v_mfma_f32_16x16x32_bf16 v[44:47], v[168:171], v[36:39], v[44:47]
  s_waitcnt vmcnt(8)
  s_cmp_ge_u32 s75, 9
  s_cbranch_scc1 L_w1520
  s_waitcnt vmcnt(7)
  s_cmp_ge_u32 s75, 8
  s_cbranch_scc1 L_w1520
  s_waitcnt vmcnt(6)
  s_cmp_ge_u32 s75, 7
  s_cbranch_scc1 L_w1520
  s_waitcnt vmcnt(5)
  s_cmp_ge_u32 s75, 6
  s_cbranch_scc1 L_w1520
  s_waitcnt vmcnt(4)
  s_cmp_ge_u32 s75, 5
  s_cbranch_scc1 L_w1520
  s_waitcnt vmcnt(3)
L_w1520:
  buffer_load_dwordx4 v[80:83], v2, s[12:15], s69 offen offset:1024 nt
  v_mfma_f32_16x16x32_bf16 v[48:51], v[172:175], v[24:27], 0
  s_waitcnt vmcnt(8)
  s_cmp_ge_u32 s74, 9
  s_cbranch_scc1 L_w1539
  s_waitcnt vmcnt(7)
  s_cmp_ge_u32 s74, 8
  s_cbranch_scc1 L_w1539
  s_waitcnt vmcnt(6)
  s_cmp_ge_u32 s74, 7
  s_cbranch_scc1 L_w1539
  s_waitcnt vmcnt(5)
  s_cmp_ge_u32 s74, 6
  s_cbranch_scc1 L_w1539
  s_waitcnt vmcnt(4)
  s_cmp_ge_u32 s74, 5
  s_cbranch_scc1 L_w1539
  s_waitcnt vmcnt(3)
L_w1539:
  buffer_load_dwordx4 v[84:87], v2, s[12:15], s69 offen offset:2048 nt
  v_cndmask_b32 v20, v44, v45, s[70:71]
  v_cndmask_b32 v21, v46, v47, s[70:71]
  s_nop 0
  v_add_f32_dpp v20, v20, v20 quad_perm:[2,3,0,1] row_mask:0xf bank_mask:0xf
  v_add_f32_dpp v21, v21, v21 quad_perm:[2,3,0,1] row_mask:0xf bank_mask:0xf
  v_cvt_pk_bf16_f32 v57, v20, v21
  v_lshlrev_b32 v10, 16, v57
  v_and_b32 v11, s67, v57
  v_mfma_f32_16x16x32_bf16 v[48:51], v[176:179], v[28:31], v[48:51]
  s_waitcnt vmcnt(8)
  s_cmp_ge_u32 s75, 9
  s_cbranch_scc1 L_w1566
  s_waitcnt vmcnt(7)
  s_cmp_ge_u32 s75, 8
  s_cbranch_scc1 L_w1566
  s_waitcnt vmcnt(6)
  s_cmp_ge_u32 s75, 7
  s_cbranch_scc1 L_w1566
  s_waitcnt vmcnt(5)
  s_cmp_ge_u32 s75, 6
  s_cbranch_scc1 L_w1566
  s_waitcnt vmcnt(4)
  s_cmp_ge_u32 s75, 5
  s_cbranch_scc1 L_w1566
  s_waitcnt vmcnt(3)
L_w1566:
  buffer_load_dwordx4 v[88:91], v2, s[12:15], s69 offen offset:3072 nt
  v_mfma_f32_16x16x32_bf16 v[48:51], v[180:183], v[32:35], v[48:51]
  s_add_u32 s69, s68, s49
  s_waitcnt vmcnt(8)
  s_cmp_ge_u32 s74, 9
  s_cbranch_scc1 L_w1586
  s_waitcnt vmcnt(7)
  s_cmp_ge_u32 s74, 8
  s_cbranch_scc1 L_w1586
  s_waitcnt vmcnt(6)
  s_cmp_ge_u32 s74, 7
  s_cbranch_scc1 L_w1586
  s_waitcnt vmcnt(5)
  s_cmp_ge_u32 s74, 6
  s_cbranch_scc1 L_w1586
  s_waitcnt vmcnt(4)
  s_cmp_ge_u32 s74, 5
  s_cbranch_scc1 L_w1586
  s_waitcnt vmcnt(3)
L_w1586:
  buffer_load_dwordx4 v[92:95], v2, s[12:15], s69 offen offset:0 nt
  v_mfma_f32_16x16x32_bf16 v[48:51], v[184:187], v[36:39], v[48:51]
  s_waitcnt vmcnt(8)
  s_cmp_ge_u32 s75, 9
  s_cbranch_scc1 L_w1605
  s_waitcnt vmcnt(7)
  s_cmp_ge_u32 s75, 8
  s_cbranch_scc1 L_w1605
  s_waitcnt vmcnt(6)
  s_cmp_ge_u32 s75, 7
  s_cbranch_scc1 L_w1605
  s_waitcnt vmcnt(5)
  s_cmp_ge_u32 s75, 6
  s_cbranch_scc1 L_w1605
  s_waitcnt vmcnt(4)
  s_cmp_ge_u32 s75, 5
  s_cbranch_scc1 L_w1605
  s_waitcnt vmcnt(3)
L_w1605:
  buffer_load_dwordx4 v[96:99], v2, s[12:15], s69 offen offset:1024 nt
  v_mfma_f32_16x16x32_bf16 v[52:55], v[188:191], v[24:27], 0
  s_waitcnt vmcnt(8)
  s_cmp_ge_u32 s74, 9
  s_cbranch_scc1 L_w1624
  s_waitcnt vmcnt(7)
  s_cmp_ge_u32 s74, 8
  s_cbranch_scc1 L_w1624
  s_waitcnt vmcnt(6)
  s_cmp_ge_u32 s74, 7
  s_cbranch_scc1 L_w1624
  s_waitcnt vmcnt(5)
  s_cmp_ge_u32 s74, 6
  s_cbranch_scc1 L_w1624
  s_waitcnt vmcnt(4)
  s_cmp_ge_u32 s74, 5
  s_cbranch_scc1 L_w1624
  s_waitcnt vmcnt(3)
L_w1624:
  buffer_load_dwordx4 v[100:103], v2, s[12:15], s69 offen offset:2048 nt
  v_cndmask_b32 v20, v48, v49, s[70:71]
  v_cndmask_b32 v21, v50, v51, s[70:71]
  s_nop 0
  v_add_f32_dpp v20, v20, v20 quad_perm:[2,3,0,1] row_mask:0xf bank_mask:0xf
  v_add_f32_dpp v21, v21, v21 quad_perm:[2,3,0,1] row_mask:0xf bank_mask:0xf
  v_cvt_pk_bf16_f32 v58, v20, v21
  v_lshlrev_b32 v12, 16, v58
  v_and_b32 v13, s67, v58
  v_mfma_f32_16x16x32_bf16 v[52:55], v[192:195], v[28:31], v[52:55]
  s_waitcnt vmcnt(8)
  s_cmp_ge_u32 s75, 9
  s_cbranch_scc1 L_w1651
  s_waitcnt vmcnt(7)
  s_cmp_ge_u32 s75, 8
  s_cbranch_scc1 L_w1651
  s_waitcnt vmcnt(6)
  s_cmp_ge_u32 s75, 7
  s_cbranch_scc1 L_w1651
  s_waitcnt vmcnt(5)
  s_cmp_ge_u32 s75, 6
  s_cbranch_scc1 L_w1651
  s_waitcnt vmcnt(4)
  s_cmp_ge_u32 s75, 5
  s_cbranch_scc1 L_w1651
  s_waitcnt vmcnt(3)
L_w1651:
  buffer_load_dwordx4 v[104:107], v2, s[12:15], s69 offen offset:3072 nt
  v_mfma_f32_16x16x32_bf16 v[52:55], v[196:199], v[32:35], v[52:55]
  s_add_u32 s69, s68, s50
  s_waitcnt vmcnt(8)
  s_cmp_ge_u32 s74, 9
  s_cbranch_scc1 L_w1671
  s_waitcnt vmcnt(7)
  s_cmp_ge_u32 s74, 8
  s_cbranch_scc1 L_w1671
  s_waitcnt vmcnt(6)
  s_cmp_ge_u32 s74, 7
  s_cbranch_scc1 L_w1671
  s_waitcnt vmcnt(5)
  s_cmp_ge_u32 s74, 6
  s_cbranch_scc1 L_w1671
  s_waitcnt vmcnt(4)
  s_cmp_ge_u32 s74, 5
  s_cbranch_scc1 L_w1671
  s_waitcnt vmcnt(3)
L_w1671:
  buffer_load_dwordx4 v[108:111], v2, s[12:15], s69 offen offset:0 nt
  v_mfma_f32_16x16x32_bf16 v[52:55], v[200:203], v[36:39], v[52:55]
  s_waitcnt vmcnt(8)
  s_cmp_ge_u32 s75, 9
  s_cbranch_scc1 L_w1690
  s_waitcnt vmcnt(7)
  s_cmp_ge_u32 s75, 8
  s_cbranch_scc1 L_w1690
  s_waitcnt vmcnt(6)
  s_cmp_ge_u32 s75, 7
  s_cbranch_scc1 L_w1690
  s_waitcnt vmcnt(5)
  s_cmp_ge_u32 s75, 6
  s_cbranch_scc1 L_w1690
  s_waitcnt vmcnt(4)
  s_cmp_ge_u32 s75, 5
  s_cbranch_scc1 L_w1690
  s_waitcnt vmcnt(3)
L_w1690:
  buffer_load_dwordx4 v[112:115], v2, s[12:15], s69 offen offset:1024 nt
  s_waitcnt vmcnt(8)
  s_cmp_ge_u32 s74, 9
  s_cbranch_scc1 L_w1708
  s_waitcnt vmcnt(7)
  s_cmp_ge_u32 s74, 8
  s_cbranch_scc1 L_w1708
  s_waitcnt vmcnt(6)
  s_cmp_ge_u32 s74, 7
  s_cbranch_scc1 L_w1708
  s_waitcnt vmcnt(5)
  s_cmp_ge_u32 s74, 6
  s_cbranch_scc1 L_w1708
  s_waitcnt vmcnt(4)
  s_cmp_ge_u32 s74, 5
  s_cbranch_scc1 L_w1708
  s_waitcnt vmcnt(3)
L_w1708:
  buffer_load_dwordx4 v[116:119], v2, s[12:15], s69 offen offset:2048 nt
  v_cndmask_b32 v20, v52, v53, s[70:71]
  v_cndmask_b32 v21, v54, v55, s[70:71]
  s_nop 0
  v_add_f32_dpp v20, v20, v20 quad_perm:[2,3,0,1] row_mask:0xf bank_mask:0xf
  v_add_f32_dpp v21, v21, v21 quad_perm:[2,3,0,1] row_mask:0xf bank_mask:0xf
  v_cvt_pk_bf16_f32 v59, v20, v21
  v_lshlrev_b32 v14, 16, v59
  v_and_b32 v15, s67, v59
  ds_write_b128 v72, v[56:59]
  v_max3_f32 v16, v8, v9, v10
  v_max3_f32 v17, v11, v12, v13
  v_max3_f32 v16, v16, v14, v15
  v_max3_f32 v16, v16, v17, v4
  v_add_u32 v72, 1024, v72
  v_sub_f32 v17, v4, v16
  v_mul_f32 v7, s66, v16
  v_mul_f32 v17, s66, v17
  v_exp_f32 v6, v17
  v_mov_b32 v4, v16
  v_fma_f32 v8, v8, s66, -v7
  v_fma_f32 v9, v9, s66, -v7
  v_fma_f32 v10, v10, s66, -v7
  v_fma_f32 v11, v11, s66, -v7
  v_fma_f32 v12, v12, s66, -v7
  v_fma_f32 v13, v13, s66, -v7
  s_waitcnt vmcnt(8)
  s_cmp_ge_u32 s75, 9
  s_cbranch_scc1 L_w1751
  s_waitcnt vmcnt(7)
  s_cmp_ge_u32 s75, 8
  s_cbranch_scc1 L_w1751
  s_waitcnt vmcnt(6)
  s_cmp_ge_u32 s75, 7
  s_cbranch_scc1 L_w1751
  s_waitcnt vmcnt(5)
  s_cmp_ge_u32 s75, 6
  s_cbranch_scc1 L_w1751
  s_waitcnt vmcnt(4)
  s_cmp_ge_u32 s75, 5
  s_cbranch_scc1 L_w1751
  s_waitcnt vmcnt(3)
L_w1751:
  buffer_load_dwordx4 v[120:123], v2, s[12:15], s69 offen offset:3072 nt
  v_fma_f32 v14, v14, s66, -v7
  v_fma_f32 v15, v15, s66, -v7
  v_exp_f32 v8, v8
  v_exp_f32 v9, v9
  v_exp_f32 v10, v10
  v_exp_f32 v11, v11
  v_exp_f32 v12, v12
  v_exp_f32 v13, v13
  v_exp_f32 v14, v14
  v_exp_f32 v15, v15
  v_add_f32 v16, v8, v9
  v_add_f32 v17, v10, v11
  v_add_f32 v18, v12, v13
  v_add_f32 v19, v14, v15
  v_add_f32 v16, v16, v17
  v_add_f32 v18, v18, v19
  v_add_f32 v16, v16, v18
  v_fma_f32 v5, v5, v6, v16
  s_add_u32 s69, s68, s51
  s_waitcnt vmcnt(8)
  s_cmp_ge_u32 s74, 9
  s_cbranch_scc1 L_w1788
  s_waitcnt vmcnt(7)
  s_cmp_ge_u32 s74, 8
  s_cbranch_scc1 L_w1788
  s_waitcnt vmcnt(6)
  s_cmp_ge_u32 s74, 7
  s_cbranch_scc1 L_w1788
  s_waitcnt vmcnt(5)
  s_cmp_ge_u32 s74, 6
  s_cbranch_scc1 L_w1788
  s_waitcnt vmcnt(4)
  s_cmp_ge_u32 s74, 5
  s_cbranch_scc1 L_w1788
  s_waitcnt vmcnt(3)
L_w1788:
  buffer_load_dwordx4 v[124:127], v2, s[12:15], s69 offen offset:0 nt
  v_mov_b32 v16, v4
  v_mov_b32 v17, v4
  s_nop 1
  v_permlane16_swap_b32 v16, v17
  v_max_f32 v16, v16, v17
  v_mov_b32 v17, v16
  s_nop 1
  v_permlane32_swap_b32 v16, v17
  v_max_f32 v16, v16, v17
  v_sub_f32 v17, v4, v16
  v_mul_f32 v17, s66, v17
  v_exp_f32 v17, v17
  v_mov_b32 v4, v16
  v_mul_f32 v3, s66, v16
  v_mul_f32 v5, v5, v17
  v_mov_b32 v17, v5
  s_nop 1
  v_permlane16_swap_b32 v5, v17
  v_add_f32 v5, v5, v17
  v_mov_b32 v17, v5
  s_nop 1
  v_permlane32_swap_b32 v5, v17
  v_add_f32 v5, v5, v17
  s_lshl_b32 s4, s3, 4
  v_lshl_add_u32 v17, v0, 3, s4
  s_mov_b64 exec, 3
  ds_write_b64 v17, v[4:5] offset:20480
  s_mov_b64 exec, -1
  v_add_u32 v72, s79, v2
  ds_read_b128 v[56:59], v72
  ds_read_b128 v[204:207], v72 offset:1024
  v_add_u32 v72, 2048, v72
  s_waitcnt vmcnt(8)
  s_cmp_ge_u32 s75, 9
  s_cbranch_scc1 L_w1838
  s_waitcnt vmcnt(7)
  s_cmp_ge_u32 s75, 8
  s_cbranch_scc1 L_w1838
  s_waitcnt vmcnt(6)
  s_cmp_ge_u32 s75, 7
  s_cbranch_scc1 L_w1838
  s_waitcnt vmcnt(5)
  s_cmp_ge_u32 s75, 6
  s_cbranch_scc1 L_w1838
  s_waitcnt vmcnt(4)
  s_cmp_ge_u32 s75, 5
  s_cbranch_scc1 L_w1838
  s_waitcnt vmcnt(3)
L_w1838:
  buffer_load_dwordx4 v[128:131], v2, s[12:15], s69 offen offset:1024 nt
  s_waitcnt lgkmcnt(0)
  v_lshlrev_b32 v8, 16, v56
  v_and_b32 v9, s67, v56
  v_lshlrev_b32 v10, 16, v57
  v_and_b32 v11, s67, v57
  v_lshlrev_b32 v12, 16, v58
  v_and_b32 v13, s67, v58
  v_lshlrev_b32 v14, 16, v59
  v_and_b32 v15, s67, v59
  v_fma_f32 v8, v8, s66, -v3
  v_fma_f32 v9, v9, s66, -v3
  v_fma_f32 v10, v10, s66, -v3
  s_waitcnt vmcnt(8)
  s_cmp_ge_u32 s74, 9
  s_cbranch_scc1 L_w1868
  s_waitcnt vmcnt(7)
  s_cmp_ge_u32 s74, 8
  s_cbranch_scc1 L_w1868
  s_waitcnt vmcnt(6)
  s_cmp_ge_u32 s74, 7
  s_cbranch_scc1 L_w1868
  s_waitcnt vmcnt(5)
  s_cmp_ge_u32 s74, 6
  s_cbranch_scc1 L_w1868
  s_waitcnt vmcnt(4)
  s_cmp_ge_u32 s74, 5
  s_cbranch_scc1 L_w1868
  s_waitcnt vmcnt(3)
L_w1868:
  buffer_load_dwordx4 v[132:135], v2, s[12:15], s69 offen offset:2048 nt
  s_memrealtime s[54:55]
  v_fma_f32 v11, v11, s66, -v3
  v_fma_f32 v12, v12, s66, -v3
  v_fma_f32 v13, v13, s66, -v3
  v_fma_f32 v14, v14, s66, -v3
  v_fma_f32 v15, v15, s66, -v3
  v_exp_f32 v8, v8
  v_exp_f32 v9, v9
  v_exp_f32 v10, v10
  v_exp_f32 v11, v11
  v_exp_f32 v12, v12
  v_exp_f32 v13, v13
  v_exp_f32 v14, v14
  s_waitcnt vmcnt(8)
  s_cmp_ge_u32 s75, 9
  s_cbranch_scc1 L_w1899
  s_waitcnt vmcnt(7)
  s_cmp_ge_u32 s75, 8
  s_cbranch_scc1 L_w1899
  s_waitcnt vmcnt(6)
  s_cmp_ge_u32 s75, 7
  s_cbranch_scc1 L_w1899
  s_waitcnt vmcnt(5)
  s_cmp_ge_u32 s75, 6
  s_cbranch_scc1 L_w1899
  s_waitcnt vmcnt(4)
  s_cmp_ge_u32 s75, 5
  s_cbranch_scc1 L_w1899
  s_waitcnt vmcnt(3)
L_w1899:
  buffer_load_dwordx4 v[136:139], v2, s[12:15], s69 offen offset:3072 nt
  s_cmp_lg_u32 s53, 0
  s_cbranch_scc1 L_tb_nb
  s_waitcnt lgkmcnt(0)
  s_mov_b32 s56, s54
  s_mov_b32 s57, s76
  s_atomic_swap_x2 s[56:57], s[36:37], s59
L_tb_nb:
  v_exp_f32 v15, v15
  v_cvt_pk_bf16_f32 v24, v8, v9
  v_cvt_pk_bf16_f32 v26, v10, v11
  v_cvt_pk_bf16_f32 v28, v12, v13
  v_cvt_pk_bf16_f32 v30, v14, v15
  v_mov_b32 v25, v24
  v_mov_b32 v27, v26
  v_mov_b32 v29, v28
  v_mov_b32 v31, v30
  v_permlane16_swap_b32 v24, v25
  v_permlane16_swap_b32 v26, v27
  v_permlane16_swap_b32 v28, v29
  v_permlane16_swap_b32 v30, v31
  s_xor_b32 s45, s46, s47
  s_bfe_u32 s4, s45, 0x40000
  s_lshl_b32 s68, s4, 17
  s_or_b32 s68, s68, s44
  s_add_u32 s46, s46, 1
  s_add_u32 s69, s68, s48
  s_waitcnt vmcnt(8)
  s_cmp_ge_u32 s74, 9
  s_cbranch_scc1 L_w1943
  s_waitcnt vmcnt(7)
  s_cmp_ge_u32 s74, 8
  s_cbranch_scc1 L_w1943
  s_waitcnt vmcnt(6)
  s_cmp_ge_u32 s74, 7
  s_cbranch_scc1 L_w1943
  s_waitcnt vmcnt(5)
  s_cmp_ge_u32 s74, 6
  s_cbranch_scc1 L_w1943
  s_waitcnt vmcnt(4)
  s_cmp_ge_u32 s74, 5
  s_cbranch_scc1 L_w1943
  s_waitcnt vmcnt(3)
L_w1943:
  buffer_load_dwordx4 v[140:143], v2, s[12:15], s69 offen offset:0 nt
  v_perm_b32 v40, v80, v76, s64
  v_perm_b32 v41, v88, v84, s64
  v_perm_b32 v42, v96, v92, s64
  v_perm_b32 v43, v104, v100, s64
  v_and_b32 v48, v24, v68
  v_and_b32 v49, v25, v68
  v_and_b32 v50, v26, v68
  v_and_b32 v51, v27, v68
  s_waitcnt vmcnt(8)
  s_cmp_ge_u32 s75, 9
  s_cbranch_scc1 L_w1969
  s_waitcnt vmcnt(7)
  s_cmp_ge_u32 s75, 8
  s_cbranch_scc1 L_w1969
  s_waitcnt vmcnt(6)
  s_cmp_ge_u32 s75, 7
  s_cbranch_scc1 L_w1969
  s_waitcnt vmcnt(5)
  s_cmp_ge_u32 s75, 6
  s_cbranch_scc1 L_w1969
  s_waitcnt vmcnt(4)
  s_cmp_ge_u32 s75, 5
  s_cbranch_scc1 L_w1969
  s_waitcnt vmcnt(3)
L_w1969:
  buffer_load_dwordx4 v[144:147], v2, s[12:15], s69 offen offset:1024 nt
  v_perm_b32 v44, v82, v78, s64
  v_perm_b32 v45, v90, v86, s64
  v_perm_b32 v46, v98, v94, s64
  v_perm_b32 v47, v106, v102, s64
  v_mfma_f32_16x16x32_bf16 v[60:63], v[40:43], v[48:51], v[60:63]
  s_waitcnt vmcnt(8)
  s_cmp_ge_u32 s74, 9
  s_cbranch_scc1 L_w1992
  s_waitcnt vmcnt(7)
  s_cmp_ge_u32 s74, 8
  s_cbranch_scc1 L_w1992
  s_waitcnt vmcnt(6)
  s_cmp_ge_u32 s74, 7
  s_cbranch_scc1 L_w1992
  s_waitcnt vmcnt(5)
  s_cmp_ge_u32 s74, 6
  s_cbranch_scc1 L_w1992
  s_waitcnt vmcnt(4)
  s_cmp_ge_u32 s74, 5
  s_cbranch_scc1 L_w1992
  s_waitcnt vmcnt(3)
L_w1992:
  buffer_load_dwordx4 v[148:151], v2, s[12:15], s69 offen offset:2048 nt
  v_perm_b32 v40, v80, v76, s65
  v_perm_b32 v41, v88, v84, s65
  v_perm_b32 v42, v96, v92, s65
  v_perm_b32 v43, v104, v100, s65
  v_and_b32 v52, v24, v69
  v_and_b32 v53, v25, v69
  v_and_b32 v54, v26, v69
  v_and_b32 v55, v27, v69
  v_mfma_f32_16x16x32_bf16 v[64:67], v[44:47], v[48:51], v[64:67]
  v_lshlrev_b32 v8, 16, v204
  v_and_b32 v9, s67, v204
  v_lshlrev_b32 v10, 16, v205
  s_waitcnt vmcnt(8)
  s_cmp_ge_u32 s75, 9
  s_cbranch_scc1 L_w2022
  s_waitcnt vmcnt(7)
  s_cmp_ge_u32 s75, 8
  s_cbranch_scc1 L_w2022
  s_waitcnt vmcnt(6)
  s_cmp_ge_u32 s75, 7
  s_cbranch_scc1 L_w2022
  s_waitcnt vmcnt(5)
  s_cmp_ge_u32 s75, 6
  s_cbranch_scc1 L_w2022
  s_waitcnt vmcnt(4)
  s_cmp_ge_u32 s75, 5
  s_cbranch_scc1 L_w2022
  s_waitcnt vmcnt(3)
L_w2022:
  buffer_load_dwordx4 v[152:155], v2, s[12:15], s69 offen offset:3072 nt
  v_perm_b32 v44, v82, v78, s65
  v_perm_b32 v45, v90, v86, s65
  v_perm_b32 v46, v98, v94, s65
  v_perm_b32 v47, v106, v102, s65
  v_mfma_f32_16x16x32_bf16 v[60:63], v[40:43], v[52:55], v[60:63]
  v_and_b32 v11, s67, v205
  v_lshlrev_b32 v12, 16, v206
  v_and_b32 v13, s67, v206
  s_add_u32 s69, s68, s49
  s_waitcnt vmcnt(8)
  s_cmp_ge_u32 s74, 9
  s_cbranch_scc1 L_w2049
  s_waitcnt vmcnt(7)
  s_cmp_ge_u32 s74, 8
  s_cbranch_scc1 L_w2049
  s_waitcnt vmcnt(6)
  s_cmp_ge_u32 s74, 7
  s_cbranch_scc1 L_w2049
  s_waitcnt vmcnt(5)
  s_cmp_ge_u32 s74, 6
  s_cbranch_scc1 L_w2049
  s_waitcnt vmcnt(4)
  s_cmp_ge_u32 s74, 5
  s_cbranch_scc1 L_w2049
  s_waitcnt vmcnt(3)
L_w2049:
  buffer_load_dwordx4 v[156:159], v2, s[12:15], s69 offen offset:0 nt
  s_barrier
  v_perm_b32 v40, v81, v77, s64
  v_perm_b32 v41, v89, v85, s64
  v_perm_b32 v42, v97, v93, s64
  v_perm_b32 v43, v105, v101, s64
  v_and_b32 v48, v24, v70
  v_and_b32 v49, v25, v70
  v_and_b32 v50, v26, v70
  v_and_b32 v51, v27, v70
  v_mfma_f32_16x16x32_bf16 v[64:67], v[44:47], v[52:55], v[64:67]
  v_lshlrev_b32 v14, 16, v207
  v_and_b32 v15, s67, v207
  v_fma_f32 v8, v8, s66, -v3
  s_waitcnt vmcnt(8)
  s_cmp_ge_u32 s75, 9
  s_cbranch_scc1 L_w2080
  s_waitcnt vmcnt(7)
  s_cmp_ge_u32 s75, 8
  s_cbranch_scc1 L_w2080
  s_waitcnt vmcnt(6)
  s_cmp_ge_u32 s75, 7
  s_cbranch_scc1 L_w2080
  s_waitcnt vmcnt(5)
  s_cmp_ge_u32 s75, 6
  s_cbranch_scc1 L_w2080
  s_waitcnt vmcnt(4)
  s_cmp_ge_u32 s75, 5
  s_cbranch_scc1 L_w2080
  s_waitcnt vmcnt(3)
L_w2080:
  buffer_load_dwordx4 v[160:163], v2, s[12:15], s69 offen offset:1024 nt
  v_perm_b32 v44, v83, v79, s64
  v_perm_b32 v45, v91, v87, s64
  v_perm_b32 v46, v99, v95, s64
  v_perm_b32 v47, v107, v103, s64
  v_mfma_f32_16x16x32_bf16 v[60:63], v[40:43], v[48:51], v[60:63]
  v_fma_f32 v9, v9, s66, -v3
  v_fma_f32 v10, v10, s66, -v3
  v_fma_f32 v11, v11, s66, -v3
  s_waitcnt vmcnt(8)
  s_cmp_ge_u32 s74, 9
  s_cbranch_scc1 L_w2106
  s_waitcnt vmcnt(7)
  s_cmp_ge_u32 s74, 8
  s_cbranch_scc1 L_w2106
  s_waitcnt vmcnt(6)
  s_cmp_ge_u32 s74, 7
  s_cbranch_scc1 L_w2106
  s_waitcnt vmcnt(5)
  s_cmp_ge_u32 s74, 6
  s_cbranch_scc1 L_w2106
  s_waitcnt vmcnt(4)
  s_cmp_ge_u32 s74, 5
  s_cbranch_scc1 L_w2106
  s_waitcnt vmcnt(3)
L_w2106:
  buffer_load_dwordx4 v[164:167], v2, s[12:15], s69 offen offset:2048 nt
  v_perm_b32 v40, v81, v77, s65
  v_perm_b32 v41, v89, v85, s65
  v_perm_b32 v42, v97, v93, s65
  v_perm_b32 v43, v105, v101, s65
  v_and_b32 v52, v24, v71
  v_and_b32 v53, v25, v71
  v_and_b32 v54, v26, v71
  v_and_b32 v55, v27, v71
  v_mfma_f32_16x16x32_bf16 v[64:67], v[44:47], v[48:51], v[64:67]
  v_fma_f32 v12, v12, s66, -v3
  v_fma_f32 v13, v13, s66, -v3
  v_fma_f32 v14, v14, s66, -v3
  s_waitcnt vmcnt(8)
  s_cmp_ge_u32 s75, 9
  s_cbranch_scc1 L_w2136
  s_waitcnt vmcnt(7)
  s_cmp_ge_u32 s75, 8
  s_cbranch_scc1 L_w2136
  s_waitcnt vmcnt(6)
  s_cmp_ge_u32 s75, 7
  s_cbranch_scc1 L_w2136
  s_waitcnt vmcnt(5)
  s_cmp_ge_u32 s75, 6
  s_cbranch_scc1 L_w2136
  s_waitcnt vmcnt(4)
  s_cmp_ge_u32 s75, 5
  s_cbranch_scc1 L_w2136
  s_waitcnt vmcnt(3)
L_w2136:
  buffer_load_dwordx4 v[168:171], v2, s[12:15], s69 offen offset:3072 nt
  v_perm_b32 v44, v83, v79, s65
  v_perm_b32 v45, v91, v87, s65
  v_perm_b32 v46, v99, v95, s65
  v_perm_b32 v47, v107, v103, s65
  v_mfma_f32_16x16x32_bf16 v[60:63], v[40:43], v[52:55], v[60:63]
  s_nop 0
  v_mfma_f32_16x16x32_bf16 v[64:67], v[44:47], v[52:55], v[64:67]
  v_fma_f32 v15, v15, s66, -v3
  v_exp_f32 v8, v8
  v_exp_f32 v9, v9
  s_add_u32 s69, s68, s50
  s_waitcnt vmcnt(8)
  s_cmp_ge_u32 s74, 9
  s_cbranch_scc1 L_w2165
  s_waitcnt vmcnt(7)
  s_cmp_ge_u32 s74, 8
  s_cbranch_scc1 L_w2165
  s_waitcnt vmcnt(6)
  s_cmp_ge_u32 s74, 7
  s_cbranch_scc1 L_w2165
  s_waitcnt vmcnt(5)
  s_cmp_ge_u32 s74, 6
  s_cbranch_scc1 L_w2165
  s_waitcnt vmcnt(4)
  s_cmp_ge_u32 s74, 5
  s_cbranch_scc1 L_w2165
  s_waitcnt vmcnt(3)
L_w2165:
  buffer_load_dwordx4 v[172:175], v2, s[12:15], s69 offen offset:0 nt
  v_perm_b32 v40, v112, v108, s64
  v_perm_b32 v41, v120, v116, s64
  v_perm_b32 v42, v128, v124, s64
  v_perm_b32 v43, v136, v132, s64
  v_and_b32 v48, v28, v68
  v_and_b32 v49, v29, v68
  v_and_b32 v50, v30, v68
  v_and_b32 v51, v31, v68
  v_exp_f32 v10, v10
  v_exp_f32 v11, v11
  v_exp_f32 v12, v12
  s_waitcnt vmcnt(8)
  s_cmp_ge_u32 s75, 9
  s_cbranch_scc1 L_w2194
  s_waitcnt vmcnt(7)
  s_cmp_ge_u32 s75, 8
  s_cbranch_scc1 L_w2194
  s_waitcnt vmcnt(6)
  s_cmp_ge_u32 s75, 7
  s_cbranch_scc1 L_w2194
  s_waitcnt vmcnt(5)
  s_cmp_ge_u32 s75, 6
  s_cbranch_scc1 L_w2194
  s_waitcnt vmcnt(4)
  s_cmp_ge_u32 s75, 5
  s_cbranch_scc1 L_w2194
  s_waitcnt vmcnt(3)
L_w2194:
  buffer_load_dwordx4 v[176:179], v2, s[12:15], s69 offen offset:1024 nt
  v_perm_b32 v44, v114, v110, s64
  v_perm_b32 v45, v122, v118, s64
  v_perm_b32 v46, v130, v126, s64
  v_perm_b32 v47, v138, v134, s64
  v_mfma_f32_16x16x32_bf16 v[60:63], v[40:43], v[48:51], v[60:63]
  v_exp_f32 v13, v13
  v_exp_f32 v14, v14
  v_exp_f32 v15, v15
  s_waitcnt vmcnt(8)
  s_cmp_ge_u32 s74, 9
  s_cbranch_scc1 L_w2220
  s_waitcnt vmcnt(7)
  s_cmp_ge_u32 s74, 8
  s_cbranch_scc1 L_w2220
  s_waitcnt vmcnt(6)
  s_cmp_ge_u32 s74, 7
  s_cbranch_scc1 L_w2220
  s_waitcnt vmcnt(5)
  s_cmp_ge_u32 s74, 6
  s_cbranch_scc1 L_w2220
  s_waitcnt vmcnt(4)
  s_cmp_ge_u32 s74, 5
  s_cbranch_scc1 L_w2220
  s_waitcnt vmcnt(3)
L_w2220:
  buffer_load_dwordx4 v[180:183], v2, s[12:15], s69 offen offset:2048 nt
  v_perm_b32 v40, v112, v108, s65
  v_perm_b32 v41, v120, v116, s65
  v_perm_b32 v42, v128, v124, s65
  v_perm_b32 v43, v136, v132, s65
  v_and_b32 v52, v28, v69
  v_and_b32 v53, v29, v69
  v_and_b32 v54, v30, v69
  v_and_b32 v55, v31, v69
  v_mfma_f32_16x16x32_bf16 v[64:67], v[44:47], v[48:51], v[64:67]
  v_cvt_pk_bf16_f32 v32, v8, v9
  v_cvt_pk_bf16_f32 v34, v10, v11
  v_cvt_pk_bf16_f32 v36, v12, v13
  s_waitcnt vmcnt(8)
  s_cmp_ge_u32 s75, 9
  s_cbranch_scc1 L_w2250
  s_waitcnt vmcnt(7)
  s_cmp_ge_u32 s75, 8
  s_cbranch_scc1 L_w2250
  s_waitcnt vmcnt(6)
  s_cmp_ge_u32 s75, 7
  s_cbranch_scc1 L_w2250
  s_waitcnt vmcnt(5)
  s_cmp_ge_u32 s75, 6
  s_cbranch_scc1 L_w2250
  s_waitcnt vmcnt(4)
  s_cmp_ge_u32 s75, 5
  s_cbranch_scc1 L_w2250
  s_waitcnt vmcnt(3)
L_w2250:
  buffer_load_dwordx4 v[184:187], v2, s[12:15], s69 offen offset:3072 nt
  v_perm_b32 v44, v114, v110, s65
  v_perm_b32 v45, v122, v118, s65
  v_perm_b32 v46, v130, v126, s65
  v_perm_b32 v47, v138, v134, s65
  v_mfma_f32_16x16x32_bf16 v[60:63], v[40:43], v[52:55], v[60:63]
  v_cvt_pk_bf16_f32 v38, v14, v15
  v_mov_b32 v33, v32
  v_mov_b32 v35, v34
  s_add_u32 s69, s68, s51
  s_waitcnt vmcnt(8)
  s_cmp_ge_u32 s74, 9
  s_cbranch_scc1 L_w2277
  s_waitcnt vmcnt(7)
  s_cmp_ge_u32 s74, 8
  s_cbranch_scc1 L_w2277
  s_waitcnt vmcnt(6)
  s_cmp_ge_u32 s74, 7
  s_cbranch_scc1 L_w2277
  s_waitcnt vmcnt(5)
  s_cmp_ge_u32 s74, 6
  s_cbranch_scc1 L_w2277
  s_waitcnt vmcnt(4)
  s_cmp_ge_u32 s74, 5
  s_cbranch_scc1 L_w2277
  s_waitcnt vmcnt(3)
L_w2277:
  buffer_load_dwordx4 v[188:191], v2, s[12:15], s69 offen offset:0 nt
  v_perm_b32 v40, v113, v109, s64
  v_perm_b32 v41, v121, v117, s64
  v_perm_b32 v42, v129, v125, s64
  v_perm_b32 v43, v137, v133, s64
  v_and_b32 v48, v28, v70
  v_and_b32 v49, v29, v70
  v_and_b32 v50, v30, v70
  v_and_b32 v51, v31, v70
  v_mfma_f32_16x16x32_bf16 v[64:67], v[44:47], v[52:55], v[64:67]
  v_mov_b32 v37, v36
  v_mov_b32 v39, v38
  v_permlane16_swap_b32 v32, v33
  s_waitcnt vmcnt(8)
  s_cmp_ge_u32 s75, 9
  s_cbranch_scc1 L_w2307
  s_waitcnt vmcnt(7)
  s_cmp_ge_u32 s75, 8
  s_cbranch_scc1 L_w2307
  s_waitcnt vmcnt(6)
  s_cmp_ge_u32 s75, 7
  s_cbranch_scc1 L_w2307
  s_waitcnt vmcnt(5)
  s_cmp_ge_u32 s75, 6
  s_cbranch_scc1 L_w2307
  s_waitcnt vmcnt(4)
  s_cmp_ge_u32 s75, 5
  s_cbranch_scc1 L_w2307
  s_waitcnt vmcnt(3)
L_w2307:
  buffer_load_dwordx4 v[192:195], v2, s[12:15], s69 offen offset:1024 nt
  s_load_dwordx16 s[16:31], s[36:37], 0
  v_perm_b32 v44, v115, v111, s64
  v_perm_b32 v45, v123, v119, s64
  v_perm_b32 v46, v131, v127, s64
  v_perm_b32 v47, v139, v135, s64
  v_mfma_f32_16x16x32_bf16 v[60:63], v[40:43], v[48:51], v[60:63]
  v_permlane16_swap_b32 v34, v35
  v_permlane16_swap_b32 v36, v37
  v_permlane16_swap_b32 v38, v39
  s_waitcnt vmcnt(8)
  s_cmp_ge_u32 s74, 9
  s_cbranch_scc1 L_w2334
  s_waitcnt vmcnt(7)
  s_cmp_ge_u32 s74, 8
  s_cbranch_scc1 L_w2334
  s_waitcnt vmcnt(6)
  s_cmp_ge_u32 s74, 7
  s_cbranch_scc1 L_w2334
  s_waitcnt vmcnt(5)
  s_cmp_ge_u32 s74, 6
  s_cbranch_scc1 L_w2334
  s_waitcnt vmcnt(4)
  s_cmp_ge_u32 s74, 5
  s_cbranch_scc1 L_w2334
  s_waitcnt vmcnt(3)
L_w2334:
  buffer_load_dwordx4 v[196:199], v2, s[12:15], s69 offen offset:2048 nt
  v_perm_b32 v40, v113, v109, s65
  v_perm_b32 v41, v121, v117, s65
  v_perm_b32 v42, v129, v125, s65
  v_perm_b32 v43, v137, v133, s65
  v_and_b32 v52, v28, v71
  v_and_b32 v53, v29, v71
  v_and_b32 v54, v30, v71
  v_and_b32 v55, v31, v71
  v_mfma_f32_16x16x32_bf16 v[64:67], v[44:47], v[48:51], v[64:67]
  s_waitcnt vmcnt(8)
  s_cmp_ge_u32 s75, 9
  s_cbranch_scc1 L_w2361
  s_waitcnt vmcnt(7)
  s_cmp_ge_u32 s75, 8
  s_cbranch_scc1 L_w2361
  s_waitcnt vmcnt(6)
  s_cmp_ge_u32 s75, 7
  s_cbranch_scc1 L_w2361
  s_waitcnt vmcnt(5)
  s_cmp_ge_u32 s75, 6
  s_cbranch_scc1 L_w2361
  s_waitcnt vmcnt(4)
  s_cmp_ge_u32 s75, 5
  s_cbranch_scc1 L_w2361
  s_waitcnt vmcnt(3)
L_w2361:
  buffer_load_dwordx4 v[200:203], v2, s[12:15], s69 offen offset:3072 nt
  v_perm_b32 v44, v115, v111, s65
  v_perm_b32 v45, v123, v119, s65
  v_perm_b32 v46, v131, v127, s65
  v_perm_b32 v47, v139, v135, s65
  v_mfma_f32_16x16x32_bf16 v[60:63], v[40:43], v[52:55], v[60:63]
  s_nop 0
  v_mfma_f32_16x16x32_bf16 v[64:67], v[44:47], v[52:55], v[64:67]
  s_branch L_next
L_vbody:
  s_xor_b32 s45, s46, s47
  s_bfe_u32 s4, s45, 0x40000
  s_lshl_b32 s68, s4, 17
  s_or_b32 s68, s68, s44
  s_add_u32 s46, s46, 1
  s_add_u32 s69, s68, s48
  s_waitcnt vmcnt(8)
  s_cmp_ge_u32 s74, 9
  s_cbranch_scc1 L_w2395
  s_waitcnt vmcnt(7)
  s_cmp_ge_u32 s74, 8
  s_cbranch_scc1 L_w2395
  s_waitcnt vmcnt(6)
  s_cmp_ge_u32 s74, 7
  s_cbranch_scc1 L_w2395
  s_waitcnt vmcnt(5)
  s_cmp_ge_u32 s74, 6
  s_cbranch_scc1 L_w2395
  s_waitcnt vmcnt(4)
  s_cmp_ge_u32 s74, 5
  s_cbranch_scc1 L_w2395
  s_waitcnt vmcnt(3)
L_w2395:
  buffer_load_dwordx4 v[76:79], v2, s[12:15], s69 offen offset:0 nt
  v_perm_b32 v40, v144, v140, s64
  v_perm_b32 v41, v152, v148, s64
  v_perm_b32 v42, v160, v156, s64
  v_perm_b32 v43, v168, v164, s64
  v_and_b32 v48, v32, v68
  v_and_b32 v49, v33, v68
  v_and_b32 v50, v34, v68
  v_and_b32 v51, v35, v68
  s_waitcnt vmcnt(8)
  s_cmp_ge_u32 s75, 9
  s_cbranch_scc1 L_w2421
  s_waitcnt vmcnt(7)
  s_cmp_ge_u32 s75, 8
  s_cbranch_scc1 L_w2421
  s_waitcnt vmcnt(6)
  s_cmp_ge_u32 s75, 7
  s_cbranch_scc1 L_w2421
  s_waitcnt vmcnt(5)
  s_cmp_ge_u32 s75, 6
  s_cbranch_scc1 L_w2421
  s_waitcnt vmcnt(4)
  s_cmp_ge_u32 s75, 5
  s_cbranch_scc1 L_w2421
  s_waitcnt vmcnt(3)
L_w2421:
  buffer_load_dwordx4 v[80:83], v2, s[12:15], s69 offen offset:1024 nt
  v_perm_b32 v44, v146, v142, s64
  v_perm_b32 v45, v154, v150, s64
  v_perm_b32 v46, v162, v158, s64
  v_perm_b32 v47, v170, v166, s64
  v_mfma_f32_16x16x32_bf16 v[60:63], v[40:43], v[48:51], v[60:63]
  ds_read_b128 v[56:59], v72
  ds_read_b128 v[204:207], v72 offset:1024
  v_add_u32 v72, 2048, v72
  s_waitcnt vmcnt(8)
  s_cmp_ge_u32 s74, 9
  s_cbranch_scc1 L_w2447
  s_waitcnt vmcnt(7)
  s_cmp_ge_u32 s74, 8
  s_cbranch_scc1 L_w2447
  s_waitcnt vmcnt(6)
  s_cmp_ge_u32 s74, 7
  s_cbranch_scc1 L_w2447
  s_waitcnt vmcnt(5)
  s_cmp_ge_u32 s74, 6
  s_cbranch_scc1 L_w2447
  s_waitcnt vmcnt(4)
  s_cmp_ge_u32 s74, 5
  s_cbranch_scc1 L_w2447
  s_waitcnt vmcnt(3)
L_w2447:
  buffer_load_dwordx4 v[84:87], v2, s[12:15], s69 offen offset:2048 nt
  v_perm_b32 v40, v144, v140, s65
  v_perm_b32 v41, v152, v148, s65
  v_perm_b32 v42, v160, v156, s65
  v_perm_b32 v43, v168, v164, s65
  v_and_b32 v52, v32, v69
  v_and_b32 v53, v33, v69
  v_and_b32 v54, v34, v69
  v_and_b32 v55, v35, v69
  v_mfma_f32_16x16x32_bf16 v[64:67], v[44:47], v[48:51], v[64:67]
  s_waitcnt vmcnt(8)
  s_cmp_ge_u32 s75, 9
  s_cbranch_scc1 L_w2474
  s_waitcnt vmcnt(7)
  s_cmp_ge_u32 s75, 8
  s_cbranch_scc1 L_w2474
  s_waitcnt vmcnt(6)
  s_cmp_ge_u32 s75, 7
  s_cbranch_scc1 L_w2474
  s_waitcnt vmcnt(5)
  s_cmp_ge_u32 s75, 6
  s_cbranch_scc1 L_w2474
  s_waitcnt vmcnt(4)
  s_cmp_ge_u32 s75, 5
  s_cbranch_scc1 L_w2474
  s_waitcnt vmcnt(3)
L_w2474:
  buffer_load_dwordx4 v[88:91], v2, s[12:15], s69 offen offset:3072 nt
  v_perm_b32 v44, v146, v142, s65
  v_perm_b32 v45, v154, v150, s65
  v_perm_b32 v46, v162, v158, s65
  v_perm_b32 v47, v170, v166, s65
  v_mfma_f32_16x16x32_bf16 v[60:63], v[40:43], v[52:55], v[60:63]
  s_add_u32 s69, s68, s49
  s_waitcnt vmcnt(8)
  s_cmp_ge_u32 s74, 9
  s_cbranch_scc1 L_w2498
  s_waitcnt vmcnt(7)
  s_cmp_ge_u32 s74, 8
  s_cbranch_scc1 L_w2498
  s_waitcnt vmcnt(6)
  s_cmp_ge_u32 s74, 7
  s_cbranch_scc1 L_w2498
  s_waitcnt vmcnt(5)
  s_cmp_ge_u32 s74, 6
  s_cbranch_scc1 L_w2498
  s_waitcnt vmcnt(4)
  s_cmp_ge_u32 s74, 5
  s_cbranch_scc1 L_w2498
  s_waitcnt vmcnt(3)
L_w2498:
  buffer_load_dwordx4 v[92:95], v2, s[12:15], s69 offen offset:0 nt
  v_perm_b32 v40, v145, v141, s64
  v_perm_b32 v41, v153, v149, s64
  v_perm_b32 v42, v161, v157, s64
  v_perm_b32 v43, v169, v165, s64
  v_and_b32 v48, v32, v70
  v_and_b32 v49, v33, v70
  v_and_b32 v50, v34, v70
  v_and_b32 v51, v35, v70
  v_mfma_f32_16x16x32_bf16 v[64:67], v[44:47], v[52:55], v[64:67]
  s_waitcnt lgkmcnt(0)
  v_lshlrev_b32 v8, 16, v56
  v_and_b32 v9, s67, v56
  v_lshlrev_b32 v10, 16, v57
  s_waitcnt vmcnt(8)
  s_cmp_ge_u32 s75, 9
  s_cbranch_scc1 L_w2529
  s_waitcnt vmcnt(7)
  s_cmp_ge_u32 s75, 8
  s_cbranch_scc1 L_w2529
  s_waitcnt vmcnt(6)
  s_cmp_ge_u32 s75, 7
  s_cbranch_scc1 L_w2529
  s_waitcnt vmcnt(5)
  s_cmp_ge_u32 s75, 6
  s_cbranch_scc1 L_w2529
  s_waitcnt vmcnt(4)
  s_cmp_ge_u32 s75, 5
  s_cbranch_scc1 L_w2529
  s_waitcnt vmcnt(3)
L_w2529:
  buffer_load_dwordx4 v[96:99], v2, s[12:15], s69 offen offset:1024 nt
  v_perm_b32 v44, v147, v143, s64
  v_perm_b32 v45, v155, v151, s64
  v_perm_b32 v46, v163, v159, s64
  v_perm_b32 v47, v171, v167, s64
  v_mfma_f32_16x16x32_bf16 v[60:63], v[40:43], v[48:51], v[60:63]
  v_and_b32 v11, s67, v57
  v_lshlrev_b32 v12, 16, v58
  v_and_b32 v13, s67, v58
  v_lshlrev_b32 v14, 16, v59
  s_waitcnt vmcnt(8)
  s_cmp_ge_u32 s74, 9
  s_cbranch_scc1 L_w2556
  s_waitcnt vmcnt(7)
  s_cmp_ge_u32 s74, 8
  s_cbranch_scc1 L_w2556
  s_waitcnt vmcnt(6)
  s_cmp_ge_u32 s74, 7
  s_cbranch_scc1 L_w2556
  s_waitcnt vmcnt(5)
  s_cmp_ge_u32 s74, 6
  s_cbranch_scc1 L_w2556
  s_waitcnt vmcnt(4)
  s_cmp_ge_u32 s74, 5
  s_cbranch_scc1 L_w2556
  s_waitcnt vmcnt(3)
L_w2556:
  buffer_load_dwordx4 v[100:103], v2, s[12:15], s69 offen offset:2048 nt
  v_perm_b32 v40, v145, v141, s65
  v_perm_b32 v41, v153, v149, s65
  v_perm_b32 v42, v161, v157, s65
  v_perm_b32 v43, v169, v165, s65
  v_and_b32 v52, v32, v71
  v_and_b32 v53, v33, v71
  v_and_b32 v54, v34, v71
  v_and_b32 v55, v35, v71
  v_mfma_f32_16x16x32_bf16 v[64:67], v[44:47], v[48:51], v[64:67]
  v_and_b32 v15, s67, v59
  v_fma_f32 v8, v8, s66, -v3
  v_fma_f32 v9, v9, s66, -v3
  v_fma_f32 v10, v10, s66, -v3
  s_waitcnt vmcnt(8)
  s_cmp_ge_u32 s75, 9
  s_cbranch_scc1 L_w2587
  s_waitcnt vmcnt(7)
  s_cmp_ge_u32 s75, 8
  s_cbranch_scc1 L_w2587
  s_waitcnt vmcnt(6)
  s_cmp_ge_u32 s75, 7
  s_cbranch_scc1 L_w2587
  s_waitcnt vmcnt(5)
  s_cmp_ge_u32 s75, 6
  s_cbranch_scc1 L_w2587
  s_waitcnt vmcnt(4)
  s_cmp_ge_u32 s75, 5
  s_cbranch_scc1 L_w2587
  s_waitcnt vmcnt(3)
L_w2587:
  buffer_load_dwordx4 v[104:107], v2, s[12:15], s69 offen offset:3072 nt
  v_perm_b32 v44, v147, v143, s65
  v_perm_b32 v45, v155, v151, s65
  v_perm_b32 v46, v163, v159, s65
  v_perm_b32 v47, v171, v167, s65
  v_mfma_f32_16x16x32_bf16 v[60:63], v[40:43], v[52:55], v[60:63]
  s_nop 0
  v_mfma_f32_16x16x32_bf16 v[64:67], v[44:47], v[52:55], v[64:67]
  v_fma_f32 v11, v11, s66, -v3
  v_fma_f32 v12, v12, s66, -v3
  v_fma_f32 v13, v13, s66, -v3
  v_fma_f32 v14, v14, s66, -v3
  s_add_u32 s69, s68, s50
  s_waitcnt vmcnt(8)
  s_cmp_ge_u32 s74, 9
  s_cbranch_scc1 L_w2617
  s_waitcnt vmcnt(7)
  s_cmp_ge_u32 s74, 8
  s_cbranch_scc1 L_w2617
  s_waitcnt vmcnt(6)
  s_cmp_ge_u32 s74, 7
  s_cbranch_scc1 L_w2617
  s_waitcnt vmcnt(5)
  s_cmp_ge_u32 s74, 6
  s_cbranch_scc1 L_w2617
  s_waitcnt vmcnt(4)
  s_cmp_ge_u32 s74, 5
  s_cbranch_scc1 L_w2617
  s_waitcnt vmcnt(3)
L_w2617:
  buffer_load_dwordx4 v[108:111], v2, s[12:15], s69 offen offset:0 nt
  v_perm_b32 v40, v176, v172, s64
  v_perm_b32 v41, v184, v180, s64
  v_perm_b32 v42, v192, v188, s64
  v_perm_b32 v43, v200, v196, s64
  v_and_b32 v48, v36, v68
  v_and_b32 v49, v37, v68
  v_and_b32 v50, v38, v68
  v_and_b32 v51, v39, v68
  v_fma_f32 v15, v15, s66, -v3
  v_exp_f32 v8, v8
  v_exp_f32 v9, v9
  v_exp_f32 v10, v10
  s_waitcnt vmcnt(8)
  s_cmp_ge_u32 s75, 9
  s_cbranch_scc1 L_w2647
  s_waitcnt vmcnt(7)
  s_cmp_ge_u32 s75, 8
  s_cbranch_scc1 L_w2647
  s_waitcnt vmcnt(6)
  s_cmp_ge_u32 s75, 7
  s_cbranch_scc1 L_w2647
  s_waitcnt vmcnt(5)
  s_cmp_ge_u32 s75, 6
  s_cbranch_scc1 L_w2647
  s_waitcnt vmcnt(4)
  s_cmp_ge_u32 s75, 5
  s_cbranch_scc1 L_w2647
  s_waitcnt vmcnt(3)
L_w2647:
  buffer_load_dwordx4 v[112:115], v2, s[12:15], s69 offen offset:1024 nt
  v_perm_b32 v44, v178, v174, s64
  v_perm_b32 v45, v186, v182, s64
  v_perm_b32 v46, v194, v190, s64
  v_perm_b32 v47, v202, v198, s64
  v_mfma_f32_16x16x32_bf16 v[60:63], v[40:43], v[48:51], v[60:63]
  v_exp_f32 v11, v11
  v_exp_f32 v12, v12
  v_exp_f32 v13, v13
  v_exp_f32 v14, v14
  s_waitcnt vmcnt(8)
  s_cmp_ge_u32 s74, 9
  s_cbranch_scc1 L_w2674
  s_waitcnt vmcnt(7)
  s_cmp_ge_u32 s74, 8
  s_cbranch_scc1 L_w2674
  s_waitcnt vmcnt(6)
  s_cmp_ge_u32 s74, 7
  s_cbranch_scc1 L_w2674
  s_waitcnt vmcnt(5)
  s_cmp_ge_u32 s74, 6
  s_cbranch_scc1 L_w2674
  s_waitcnt vmcnt(4)
  s_cmp_ge_u32 s74, 5
  s_cbranch_scc1 L_w2674
  s_waitcnt vmcnt(3)
L_w2674:
  buffer_load_dwordx4 v[116:119], v2, s[12:15], s69 offen offset:2048 nt
  v_perm_b32 v40, v176, v172, s65
  v_perm_b32 v41, v184, v180, s65
  v_perm_b32 v42, v192, v188, s65
  v_perm_b32 v43, v200, v196, s65
  v_and_b32 v52, v36, v69
  v_and_b32 v53, v37, v69
  v_and_b32 v54, v38, v69
  v_and_b32 v55, v39, v69
  v_mfma_f32_16x16x32_bf16 v[64:67], v[44:47], v[48:51], v[64:67]
  v_exp_f32 v15, v15
  v_cvt_pk_bf16_f32 v24, v8, v9
  v_cvt_pk_bf16_f32 v26, v10, v11
  v_cvt_pk_bf16_f32 v28, v12, v13
  s_waitcnt vmcnt(8)
  s_cmp_ge_u32 s75, 9
  s_cbranch_scc1 L_w2705
  s_waitcnt vmcnt(7)
  s_cmp_ge_u32 s75, 8
  s_cbranch_scc1 L_w2705
  s_waitcnt vmcnt(6)
  s_cmp_ge_u32 s75, 7
  s_cbranch_scc1 L_w2705
  s_waitcnt vmcnt(5)
  s_cmp_ge_u32 s75, 6
  s_cbranch_scc1 L_w2705
  s_waitcnt vmcnt(4)
  s_cmp_ge_u32 s75, 5
  s_cbranch_scc1 L_w2705
  s_waitcnt vmcnt(3)
L_w2705:
  buffer_load_dwordx4 v[120:123], v2, s[12:15], s69 offen offset:3072 nt
  v_perm_b32 v44, v178, v174, s65
  v_perm_b32 v45, v186, v182, s65
  v_perm_b32 v46, v194, v190, s65
  v_perm_b32 v47, v202, v198, s65
  v_mfma_f32_16x16x32_bf16 v[60:63], v[40:43], v[52:55], v[60:63]
  v_cvt_pk_bf16_f32 v30, v14, v15
  v_mov_b32 v25, v24
  v_mov_b32 v27, v26
  v_mov_b32 v29, v28
  s_add_u32 s69, s68, s51
  s_waitcnt vmcnt(8)
  s_cmp_ge_u32 s74, 9
  s_cbranch_scc1 L_w2733
  s_waitcnt vmcnt(7)
  s_cmp_ge_u32 s74, 8
  s_cbranch_scc1 L_w2733
  s_waitcnt vmcnt(6)
  s_cmp_ge_u32 s74, 7
  s_cbranch_scc1 L_w2733
  s_waitcnt vmcnt(5)
  s_cmp_ge_u32 s74, 6
  s_cbranch_scc1 L_w2733
  s_waitcnt vmcnt(4)
  s_cmp_ge_u32 s74, 5
  s_cbranch_scc1 L_w2733
  s_waitcnt vmcnt(3)
L_w2733:
  buffer_load_dwordx4 v[124:127], v2, s[12:15], s69 offen offset:0 nt
  v_perm_b32 v40, v177, v173, s64
  v_perm_b32 v41, v185, v181, s64
  v_perm_b32 v42, v193, v189, s64
  v_perm_b32 v43, v201, v197, s64
  v_and_b32 v48, v36, v70
  v_and_b32 v49, v37, v70
  v_and_b32 v50, v38, v70
  v_and_b32 v51, v39, v70
  v_mfma_f32_16x16x32_bf16 v[64:67], v[44:47], v[52:55], v[64:67]
  v_mov_b32 v31, v30
  v_permlane16_swap_b32 v24, v25
  v_permlane16_swap_b32 v26, v27
  v_permlane16_swap_b32 v28, v29
  v_permlane16_swap_b32 v30, v31
  s_waitcnt vmcnt(8)
  s_cmp_ge_u32 s75, 9
  s_cbranch_scc1 L_w2765
  s_waitcnt vmcnt(7)
  s_cmp_ge_u32 s75, 8
  s_cbranch_scc1 L_w2765
  s_waitcnt vmcnt(6)
  s_cmp_ge_u32 s75, 7
  s_cbranch_scc1 L_w2765
  s_waitcnt vmcnt(5)
  s_cmp_ge_u32 s75, 6
  s_cbranch_scc1 L_w2765
  s_waitcnt vmcnt(4)
  s_cmp_ge_u32 s75, 5
  s_cbranch_scc1 L_w2765
  s_waitcnt vmcnt(3)
L_w2765:
  buffer_load_dwordx4 v[128:131], v2, s[12:15], s69 offen offset:1024 nt
  v_perm_b32 v44, v179, v175, s64
  v_perm_b32 v45, v187, v183, s64
  v_perm_b32 v46, v195, v191, s64
  v_perm_b32 v47, v203, v199, s64
  v_mfma_f32_16x16x32_bf16 v[60:63], v[40:43], v[48:51], v[60:63]
  s_waitcnt vmcnt(8)
  s_cmp_ge_u32 s74, 9
  s_cbranch_scc1 L_w2788
  s_waitcnt vmcnt(7)
  s_cmp_ge_u32 s74, 8
  s_cbranch_scc1 L_w2788
  s_waitcnt vmcnt(6)
  s_cmp_ge_u32 s74, 7
  s_cbranch_scc1 L_w2788
  s_waitcnt vmcnt(5)
  s_cmp_ge_u32 s74, 6
  s_cbranch_scc1 L_w2788
  s_waitcnt vmcnt(4)
  s_cmp_ge_u32 s74, 5
  s_cbranch_scc1 L_w2788
  s_waitcnt vmcnt(3)
L_w2788:
  buffer_load_dwordx4 v[132:135], v2, s[12:15], s69 offen offset:2048 nt
  s_memrealtime s[54:55]
  v_perm_b32 v40, v177, v173, s65
  v_perm_b32 v41, v185, v181, s65
  v_perm_b32 v42, v193, v189, s65
  v_perm_b32 v43, v201, v197, s65
  v_and_b32 v52, v36, v71
  v_and_b32 v53, v37, v71
  v_and_b32 v54, v38, v71
  v_and_b32 v55, v39, v71
  v_mfma_f32_16x16x32_bf16 v[64:67], v[44:47], v[48:51], v[64:67]
  s_waitcnt vmcnt(8)
  s_cmp_ge_u32 s75, 9
  s_cbranch_scc1 L_w2816
  s_waitcnt vmcnt(7)
  s_cmp_ge_u32 s75, 8
  s_cbranch_scc1 L_w2816
  s_waitcnt vmcnt(6)
  s_cmp_ge_u32 s75, 7
  s_cbranch_scc1 L_w2816
  s_waitcnt vmcnt(5)
  s_cmp_ge_u32 s75, 6
  s_cbranch_scc1 L_w2816
  s_waitcnt vmcnt(4)
  s_cmp_ge_u32 s75, 5
  s_cbranch_scc1 L_w2816
  s_waitcnt vmcnt(3)
L_w2816:
  buffer_load_dwordx4 v[136:139], v2, s[12:15], s69 offen offset:3072 nt
  s_cmp_lg_u32 s53, 0
  s_cbranch_scc1 L_vb_nb
  s_waitcnt lgkmcnt(0)
  s_mov_b32 s56, s54
  s_mov_b32 s57, s76
  s_atomic_swap_x2 s[56:57], s[36:37], s59
L_vb_nb:
  v_perm_b32 v44, v179, v175, s65
  v_perm_b32 v45, v187, v183, s65
  v_perm_b32 v46, v195, v191, s65
  v_perm_b32 v47, v203, v199, s65
  v_mfma_f32_16x16x32_bf16 v[60:63], v[40:43], v[52:55], v[60:63]
  s_nop 0
  v_mfma_f32_16x16x32_bf16 v[64:67], v[44:47], v[52:55], v[64:67]
  s_xor_b32 s45, s46, s47
  s_bfe_u32 s4, s45, 0x40000
  s_lshl_b32 s68, s4, 17
  s_or_b32 s68, s68, s44
  s_add_u32 s46, s46, 1
  s_add_u32 s69, s68, s48
  s_waitcnt vmcnt(8)
  s_cmp_ge_u32 s74, 9
  s_cbranch_scc1 L_w2854
  s_waitcnt vmcnt(7)
  s_cmp_ge_u32 s74, 8
  s_cbranch_scc1 L_w2854
  s_waitcnt vmcnt(6)
  s_cmp_ge_u32 s74, 7
  s_cbranch_scc1 L_w2854
  s_waitcnt vmcnt(5)
  s_cmp_ge_u32 s74, 6
  s_cbranch_scc1 L_w2854
  s_waitcnt vmcnt(4)
  s_cmp_ge_u32 s74, 5
  s_cbranch_scc1 L_w2854
  s_waitcnt vmcnt(3)
L_w2854:
  buffer_load_dwordx4 v[140:143], v2, s[12:15], s69 offen offset:0 nt
  v_perm_b32 v40, v80, v76, s64
  v_perm_b32 v41, v88, v84, s64
  v_perm_b32 v42, v96, v92, s64
  v_perm_b32 v43, v104, v100, s64
  v_and_b32 v48, v24, v68
  v_and_b32 v49, v25, v68
  v_and_b32 v50, v26, v68
  v_and_b32 v51, v27, v68
  s_waitcnt vmcnt(8)
  s_cmp_ge_u32 s75, 9
  s_cbranch_scc1 L_w2880
  s_waitcnt vmcnt(7)
  s_cmp_ge_u32 s75, 8
  s_cbranch_scc1 L_w2880
  s_waitcnt vmcnt(6)
  s_cmp_ge_u32 s75, 7
  s_cbranch_scc1 L_w2880
  s_waitcnt vmcnt(5)
  s_cmp_ge_u32 s75, 6
  s_cbranch_scc1 L_w2880
  s_waitcnt vmcnt(4)
  s_cmp_ge_u32 s75, 5
  s_cbranch_scc1 L_w2880
  s_waitcnt vmcnt(3)
L_w2880:
  buffer_load_dwordx4 v[144:147], v2, s[12:15], s69 offen offset:1024 nt
  v_perm_b32 v44, v82, v78, s64
  v_perm_b32 v45, v90, v86, s64
  v_perm_b32 v46, v98, v94, s64
  v_perm_b32 v47, v106, v102, s64
  v_mfma_f32_16x16x32_bf16 v[60:63], v[40:43], v[48:51], v[60:63]
  s_waitcnt vmcnt(8)
  s_cmp_ge_u32 s74, 9
  s_cbranch_scc1 L_w2903
  s_waitcnt vmcnt(7)
  s_cmp_ge_u32 s74, 8
  s_cbranch_scc1 L_w2903
  s_waitcnt vmcnt(6)
  s_cmp_ge_u32 s74, 7
  s_cbranch_scc1 L_w2903
  s_waitcnt vmcnt(5)
  s_cmp_ge_u32 s74, 6
  s_cbranch_scc1 L_w2903
  s_waitcnt vmcnt(4)
  s_cmp_ge_u32 s74, 5
  s_cbranch_scc1 L_w2903
  s_waitcnt vmcnt(3)
L_w2903:
  buffer_load_dwordx4 v[148:151], v2, s[12:15], s69 offen offset:2048 nt
  v_perm_b32 v40, v80, v76, s65
  v_perm_b32 v41, v88, v84, s65
  v_perm_b32 v42, v96, v92, s65
  v_perm_b32 v43, v104, v100, s65
  v_and_b32 v52, v24, v69
  v_and_b32 v53, v25, v69
  v_and_b32 v54, v26, v69
  v_and_b32 v55, v27, v69
  v_mfma_f32_16x16x32_bf16 v[64:67], v[44:47], v[48:51], v[64:67]
  v_lshlrev_b32 v8, 16, v204
  v_and_b32 v9, s67, v204
  v_lshlrev_b32 v10, 16, v205
  s_waitcnt vmcnt(8)
  s_cmp_ge_u32 s75, 9
  s_cbranch_scc1 L_w2933
  s_waitcnt vmcnt(7)
  s_cmp_ge_u32 s75, 8
  s_cbranch_scc1 L_w2933
  s_waitcnt vmcnt(6)
  s_cmp_ge_u32 s75, 7
  s_cbranch_scc1 L_w2933
  s_waitcnt vmcnt(5)
  s_cmp_ge_u32 s75, 6
  s_cbranch_scc1 L_w2933
  s_waitcnt vmcnt(4)
  s_cmp_ge_u32 s75, 5
  s_cbranch_scc1 L_w2933
  s_waitcnt vmcnt(3)
L_w2933:
  buffer_load_dwordx4 v[152:155], v2, s[12:15], s69 offen offset:3072 nt
  v_perm_b32 v44, v82, v78, s65
  v_perm_b32 v45, v90, v86, s65
  v_perm_b32 v46, v98, v94, s65
  v_perm_b32 v47, v106, v102, s65
  v_mfma_f32_16x16x32_bf16 v[60:63], v[40:43], v[52:55], v[60:63]
  v_and_b32 v11, s67, v205
  v_lshlrev_b32 v12, 16, v206
  v_and_b32 v13, s67, v206
  s_add_u32 s69, s68, s49
  s_waitcnt vmcnt(8)
  s_cmp_ge_u32 s74, 9
  s_cbranch_scc1 L_w2960
  s_waitcnt vmcnt(7)
  s_cmp_ge_u32 s74, 8
  s_cbranch_scc1 L_w2960
  s_waitcnt vmcnt(6)
  s_cmp_ge_u32 s74, 7
  s_cbranch_scc1 L_w2960
  s_waitcnt vmcnt(5)
  s_cmp_ge_u32 s74, 6
  s_cbranch_scc1 L_w2960
  s_waitcnt vmcnt(4)
  s_cmp_ge_u32 s74, 5
  s_cbranch_scc1 L_w2960
  s_waitcnt vmcnt(3)
L_w2960:
  buffer_load_dwordx4 v[156:159], v2, s[12:15], s69 offen offset:0 nt
  v_perm_b32 v40, v81, v77, s64
  v_perm_b32 v41, v89, v85, s64
  v_perm_b32 v42, v97, v93, s64
  v_perm_b32 v43, v105, v101, s64
  v_and_b32 v48, v24, v70
  v_and_b32 v49, v25, v70
  v_and_b32 v50, v26, v70
  v_and_b32 v51, v27, v70
  v_mfma_f32_16x16x32_bf16 v[64:67], v[44:47], v[52:55], v[64:67]
  v_lshlrev_b32 v14, 16, v207
  v_and_b32 v15, s67, v207
  v_fma_f32 v8, v8, s66, -v3
  s_waitcnt vmcnt(8)
  s_cmp_ge_u32 s75, 9
  s_cbranch_scc1 L_w2990
  s_waitcnt vmcnt(7)
  s_cmp_ge_u32 s75, 8
  s_cbranch_scc1 L_w2990
  s_waitcnt vmcnt(6)
  s_cmp_ge_u32 s75, 7
  s_cbranch_scc1 L_w2990
  s_waitcnt vmcnt(5)
  s_cmp_ge_u32 s75, 6
  s_cbranch_scc1 L_w2990
  s_waitcnt vmcnt(4)
  s_cmp_ge_u32 s75, 5
  s_cbranch_scc1 L_w2990
  s_waitcnt vmcnt(3)
L_w2990:
  buffer_load_dwordx4 v[160:163], v2, s[12:15], s69 offen offset:1024 nt
  v_perm_b32 v44, v83, v79, s64
  v_perm_b32 v45, v91, v87, s64
  v_perm_b32 v46, v99, v95, s64
  v_perm_b32 v47, v107, v103, s64
  v_mfma_f32_16x16x32_bf16 v[60:63], v[40:43], v[48:51], v[60:63]
  v_fma_f32 v9, v9, s66, -v3
  v_fma_f32 v10, v10, s66, -v3
  v_fma_f32 v11, v11, s66, -v3
  s_waitcnt vmcnt(8)
  s_cmp_ge_u32 s74, 9
  s_cbranch_scc1 L_w3016
  s_waitcnt vmcnt(7)
  s_cmp_ge_u32 s74, 8
  s_cbranch_scc1 L_w3016
  s_waitcnt vmcnt(6)
  s_cmp_ge_u32 s74, 7
  s_cbranch_scc1 L_w3016
  s_waitcnt vmcnt(5)
  s_cmp_ge_u32 s74, 6
  s_cbranch_scc1 L_w3016
  s_waitcnt vmcnt(4)
  s_cmp_ge_u32 s74, 5
  s_cbranch_scc1 L_w3016
  s_waitcnt vmcnt(3)
L_w3016:
  buffer_load_dwordx4 v[164:167], v2, s[12:15], s69 offen offset:2048 nt
  v_perm_b32 v40, v81, v77, s65
  v_perm_b32 v41, v89, v85, s65
  v_perm_b32 v42, v97, v93, s65
  v_perm_b32 v43, v105, v101, s65
  v_and_b32 v52, v24, v71
  v_and_b32 v53, v25, v71
  v_and_b32 v54, v26, v71
  v_and_b32 v55, v27, v71
  v_mfma_f32_16x16x32_bf16 v[64:67], v[44:47], v[48:51], v[64:67]
  v_fma_f32 v12, v12, s66, -v3
  v_fma_f32 v13, v13, s66, -v3
  v_fma_f32 v14, v14, s66, -v3
  s_waitcnt vmcnt(8)
  s_cmp_ge_u32 s75, 9
  s_cbranch_scc1 L_w3046
  s_waitcnt vmcnt(7)
  s_cmp_ge_u32 s75, 8
  s_cbranch_scc1 L_w3046
  s_waitcnt vmcnt(6)
  s_cmp_ge_u32 s75, 7
  s_cbranch_scc1 L_w3046
  s_waitcnt vmcnt(5)
  s_cmp_ge_u32 s75, 6
  s_cbranch_scc1 L_w3046
  s_waitcnt vmcnt(4)
  s_cmp_ge_u32 s75, 5
  s_cbranch_scc1 L_w3046
  s_waitcnt vmcnt(3)
L_w3046:
  buffer_load_dwordx4 v[168:171], v2, s[12:15], s69 offen offset:3072 nt
  v_perm_b32 v44, v83, v79, s65
  v_perm_b32 v45, v91, v87, s65
  v_perm_b32 v46, v99, v95, s65
  v_perm_b32 v47, v107, v103, s65
  v_mfma_f32_16x16x32_bf16 v[60:63], v[40:43], v[52:55], v[60:63]
  s_nop 0
  v_mfma_f32_16x16x32_bf16 v[64:67], v[44:47], v[52:55], v[64:67]
  v_fma_f32 v15, v15, s66, -v3
  v_exp_f32 v8, v8
  v_exp_f32 v9, v9
  s_add_u32 s69, s68, s50
  s_waitcnt vmcnt(8)
  s_cmp_ge_u32 s74, 9
  s_cbranch_scc1 L_w3075
  s_waitcnt vmcnt(7)
  s_cmp_ge_u32 s74, 8
  s_cbranch_scc1 L_w3075
  s_waitcnt vmcnt(6)
  s_cmp_ge_u32 s74, 7
  s_cbranch_scc1 L_w3075
  s_waitcnt vmcnt(5)
  s_cmp_ge_u32 s74, 6
  s_cbranch_scc1 L_w3075
  s_waitcnt vmcnt(4)
  s_cmp_ge_u32 s74, 5
  s_cbranch_scc1 L_w3075
  s_waitcnt vmcnt(3)
L_w3075:
  buffer_load_dwordx4 v[172:175], v2, s[12:15], s69 offen offset:0 nt
  v_perm_b32 v40, v112, v108, s64
  v_perm_b32 v41, v120, v116, s64
  v_perm_b32 v42, v128, v124, s64
  v_perm_b32 v43, v136, v132, s64
  v_and_b32 v48, v28, v68
  v_and_b32 v49, v29, v68
  v_and_b32 v50, v30, v68
  v_and_b32 v51, v31, v68
  v_exp_f32 v10, v10
  v_exp_f32 v11, v11
  v_exp_f32 v12, v12
  s_waitcnt vmcnt(8)
  s_cmp_ge_u32 s75, 9
  s_cbranch_scc1 L_w3104
  s_waitcnt vmcnt(7)
  s_cmp_ge_u32 s75, 8
  s_cbranch_scc1 L_w3104
  s_waitcnt vmcnt(6)
  s_cmp_ge_u32 s75, 7
  s_cbranch_scc1 L_w3104
  s_waitcnt vmcnt(5)
  s_cmp_ge_u32 s75, 6
  s_cbranch_scc1 L_w3104
  s_waitcnt vmcnt(4)
  s_cmp_ge_u32 s75, 5
  s_cbranch_scc1 L_w3104
  s_waitcnt vmcnt(3)
L_w3104:
  buffer_load_dwordx4 v[176:179], v2, s[12:15], s69 offen offset:1024 nt
  v_perm_b32 v44, v114, v110, s64
  v_perm_b32 v45, v122, v118, s64
  v_perm_b32 v46, v130, v126, s64
  v_perm_b32 v47, v138, v134, s64
  v_mfma_f32_16x16x32_bf16 v[60:63], v[40:43], v[48:51], v[60:63]
  v_exp_f32 v13, v13
  v_exp_f32 v14, v14
  v_exp_f32 v15, v15
  s_waitcnt vmcnt(8)
  s_cmp_ge_u32 s74, 9
  s_cbranch_scc1 L_w3130
  s_waitcnt vmcnt(7)
  s_cmp_ge_u32 s74, 8
  s_cbranch_scc1 L_w3130
  s_waitcnt vmcnt(6)
  s_cmp_ge_u32 s74, 7
  s_cbranch_scc1 L_w3130
  s_waitcnt vmcnt(5)
  s_cmp_ge_u32 s74, 6
  s_cbranch_scc1 L_w3130
  s_waitcnt vmcnt(4)
  s_cmp_ge_u32 s74, 5
  s_cbranch_scc1 L_w3130
  s_waitcnt vmcnt(3)
L_w3130:
  buffer_load_dwordx4 v[180:183], v2, s[12:15], s69 offen offset:2048 nt
  v_perm_b32 v40, v112, v108, s65
  v_perm_b32 v41, v120, v116, s65
  v_perm_b32 v42, v128, v124, s65
  v_perm_b32 v43, v136, v132, s65
  v_and_b32 v52, v28, v69
  v_and_b32 v53, v29, v69
  v_and_b32 v54, v30, v69
  v_and_b32 v55, v31, v69
  v_mfma_f32_16x16x32_bf16 v[64:67], v[44:47], v[48:51], v[64:67]
  v_cvt_pk_bf16_f32 v32, v8, v9
  v_cvt_pk_bf16_f32 v34, v10, v11
  v_cvt_pk_bf16_f32 v36, v12, v13
  s_waitcnt vmcnt(8)
  s_cmp_ge_u32 s75, 9
  s_cbranch_scc1 L_w3160
  s_waitcnt vmcnt(7)
  s_cmp_ge_u32 s75, 8
  s_cbranch_scc1 L_w3160
  s_waitcnt vmcnt(6)
  s_cmp_ge_u32 s75, 7
  s_cbranch_scc1 L_w3160
  s_waitcnt vmcnt(5)
  s_cmp_ge_u32 s75, 6
  s_cbranch_scc1 L_w3160
  s_waitcnt vmcnt(4)
  s_cmp_ge_u32 s75, 5
  s_cbranch_scc1 L_w3160
  s_waitcnt vmcnt(3)
L_w3160:
  buffer_load_dwordx4 v[184:187], v2, s[12:15], s69 offen offset:3072 nt
  v_perm_b32 v44, v114, v110, s65
  v_perm_b32 v45, v122, v118, s65
  v_perm_b32 v46, v130, v126, s65
  v_perm_b32 v47, v138, v134, s65
  v_mfma_f32_16x16x32_bf16 v[60:63], v[40:43], v[52:55], v[60:63]
  v_cvt_pk_bf16_f32 v38, v14, v15
  v_mov_b32 v33, v32
  v_mov_b32 v35, v34
  s_add_u32 s69, s68, s51
  s_waitcnt vmcnt(8)
  s_cmp_ge_u32 s74, 9
  s_cbranch_scc1 L_w3187
  s_waitcnt vmcnt(7)
  s_cmp_ge_u32 s74, 8
  s_cbranch_scc1 L_w3187
  s_waitcnt vmcnt(6)
  s_cmp_ge_u32 s74, 7
  s_cbranch_scc1 L_w3187
  s_waitcnt vmcnt(5)
  s_cmp_ge_u32 s74, 6
  s_cbranch_scc1 L_w3187
  s_waitcnt vmcnt(4)
  s_cmp_ge_u32 s74, 5
  s_cbranch_scc1 L_w3187
  s_waitcnt vmcnt(3)
L_w3187:
  buffer_load_dwordx4 v[188:191], v2, s[12:15], s69 offen offset:0 nt
  v_perm_b32 v40, v113, v109, s64
  v_perm_b32 v41, v121, v117, s64
  v_perm_b32 v42, v129, v125, s64
  v_perm_b32 v43, v137, v133, s64
  v_and_b32 v48, v28, v70
  v_and_b32 v49, v29, v70
  v_and_b32 v50, v30, v70
  v_and_b32 v51, v31, v70
  v_mfma_f32_16x16x32_bf16 v[64:67], v[44:47], v[52:55], v[64:67]
  v_mov_b32 v37, v36
  v_mov_b32 v39, v38
  v_permlane16_swap_b32 v32, v33
  s_waitcnt vmcnt(8)
  s_cmp_ge_u32 s75, 9
  s_cbranch_scc1 L_w3217
  s_waitcnt vmcnt(7)
  s_cmp_ge_u32 s75, 8
  s_cbranch_scc1 L_w3217
  s_waitcnt vmcnt(6)
  s_cmp_ge_u32 s75, 7
  s_cbranch_scc1 L_w3217
  s_waitcnt vmcnt(5)
  s_cmp_ge_u32 s75, 6
  s_cbranch_scc1 L_w3217
  s_waitcnt vmcnt(4)
  s_cmp_ge_u32 s75, 5
  s_cbranch_scc1 L_w3217
  s_waitcnt vmcnt(3)
L_w3217:
  buffer_load_dwordx4 v[192:195], v2, s[12:15], s69 offen offset:1024 nt
  s_load_dwordx16 s[16:31], s[36:37], 0
  v_perm_b32 v44, v115, v111, s64
  v_perm_b32 v45, v123, v119, s64
  v_perm_b32 v46, v131, v127, s64
  v_perm_b32 v47, v139, v135, s64
  v_mfma_f32_16x16x32_bf16 v[60:63], v[40:43], v[48:51], v[60:63]
  v_permlane16_swap_b32 v34, v35
  v_permlane16_swap_b32 v36, v37
  v_permlane16_swap_b32 v38, v39
  s_waitcnt vmcnt(8)
  s_cmp_ge_u32 s74, 9
  s_cbranch_scc1 L_w3244
  s_waitcnt vmcnt(7)
  s_cmp_ge_u32 s74, 8
  s_cbranch_scc1 L_w3244
  s_waitcnt vmcnt(6)
  s_cmp_ge_u32 s74, 7
  s_cbranch_scc1 L_w3244
  s_waitcnt vmcnt(5)
  s_cmp_ge_u32 s74, 6
  s_cbranch_scc1 L_w3244
  s_waitcnt vmcnt(4)
  s_cmp_ge_u32 s74, 5
  s_cbranch_scc1 L_w3244
  s_waitcnt vmcnt(3)
L_w3244:
  buffer_load_dwordx4 v[196:199], v2, s[12:15], s69 offen offset:2048 nt
  v_perm_b32 v40, v113, v109, s65
  v_perm_b32 v41, v121, v117, s65
  v_perm_b32 v42, v129, v125, s65
  v_perm_b32 v43, v137, v133, s65
  v_and_b32 v52, v28, v71
  v_and_b32 v53, v29, v71
  v_and_b32 v54, v30, v71
  v_and_b32 v55, v31, v71
  v_mfma_f32_16x16x32_bf16 v[64:67], v[44:47], v[48:51], v[64:67]
  s_waitcnt vmcnt(8)
  s_cmp_ge_u32 s75, 9
  s_cbranch_scc1 L_w3271
  s_waitcnt vmcnt(7)
  s_cmp_ge_u32 s75, 8
  s_cbranch_scc1 L_w3271
  s_waitcnt vmcnt(6)
  s_cmp_ge_u32 s75, 7
  s_cbranch_scc1 L_w3271
  s_waitcnt vmcnt(5)
  s_cmp_ge_u32 s75, 6
  s_cbranch_scc1 L_w3271
  s_waitcnt vmcnt(4)
  s_cmp_ge_u32 s75, 5
  s_cbranch_scc1 L_w3271
  s_waitcnt vmcnt(3)
L_w3271:
  buffer_load_dwordx4 v[200:203], v2, s[12:15], s69 offen offset:3072 nt
  v_perm_b32 v44, v115, v111, s65
  v_perm_b32 v45, v123, v119, s65
  v_perm_b32 v46, v131, v127, s65
  v_perm_b32 v47, v139, v135, s65
  v_mfma_f32_16x16x32_bf16 v[60:63], v[40:43], v[52:55], v[60:63]
  s_nop 0
  v_mfma_f32_16x16x32_bf16 v[64:67], v[44:47], v[52:55], v[64:67]
  s_branch L_next
L_loopdone:
  s_barrier
  s_and_b32 s4, s3, 1
  s_lshl_b32 s4, s4, 3
  v_mov_b32 v11, s4
  ds_read_b32 v16, v11 offset:20480
  ds_read_b32 v17, v11 offset:20496
  ds_read_b32 v18, v11 offset:20512
  ds_read_b32 v19, v11 offset:20528
  s_waitcnt vmcnt(8)
  v_perm_b32 v40, v144, v140, s64
  v_perm_b32 v41, v152, v148, s64
  v_perm_b32 v42, v160, v156, s64
  v_perm_b32 v43, v168, v164, s64
  v_and_b32 v48, v32, v68
  v_and_b32 v49, v33, v68
  v_and_b32 v50, v34, v68
  v_and_b32 v51, v35, v68
  v_perm_b32 v44, v146, v142, s64
  v_perm_b32 v45, v154, v150, s64
  v_perm_b32 v46, v162, v158, s64
  v_perm_b32 v47, v170, v166, s64
  v_mfma_f32_16x16x32_bf16 v[60:63], v[40:43], v[48:51], v[60:63]
  v_perm_b32 v40, v144, v140, s65
  v_perm_b32 v41, v152, v148, s65
  v_perm_b32 v42, v160, v156, s65
  v_perm_b32 v43, v168, v164, s65
  v_and_b32 v52, v32, v69
  v_and_b32 v53, v33, v69
  v_and_b32 v54, v34, v69
  v_and_b32 v55, v35, v69
  v_mfma_f32_16x16x32_bf16 v[64:67], v[44:47], v[48:51], v[64:67]
  v_perm_b32 v44, v146, v142, s65
  v_perm_b32 v45, v154, v150, s65
  v_perm_b32 v46, v162, v158, s65
  v_perm_b32 v47, v170, v166, s65
  v_mfma_f32_16x16x32_bf16 v[60:63], v[40:43], v[52:55], v[60:63]
  v_perm_b32 v40, v145, v141, s64
  v_perm_b32 v41, v153, v149, s64
  v_perm_b32 v42, v161, v157, s64
  v_perm_b32 v43, v169, v165, s64
  v_and_b32 v48, v32, v70
  v_and_b32 v49, v33, v70
  v_and_b32 v50, v34, v70
  v_and_b32 v51, v35, v70
  v_mfma_f32_16x16x32_bf16 v[64:67], v[44:47], v[52:55], v[64:67]
  v_perm_b32 v44, v147, v143, s64
  v_perm_b32 v45, v155, v151, s64
  v_perm_b32 v46, v163, v159, s64
  v_perm_b32 v47, v171, v167, s64
  v_mfma_f32_16x16x32_bf16 v[60:63], v[40:43], v[48:51], v[60:63]
  v_perm_b32 v40, v145, v141, s65
  v_perm_b32 v41, v153, v149, s65
  v_perm_b32 v42, v161, v157, s65
  v_perm_b32 v43, v169, v165, s65
  v_and_b32 v52, v32, v71
  v_and_b32 v53, v33, v71
  v_and_b32 v54, v34, v71
  v_and_b32 v55, v35, v71
  v_mfma_f32_16x16x32_bf16 v[64:67], v[44:47], v[48:51], v[64:67]
  v_perm_b32 v44, v147, v143, s65
  v_perm_b32 v45, v155, v151, s65
  v_perm_b32 v46, v163, v159, s65
  v_perm_b32 v47, v171, v167, s65
  v_mfma_f32_16x16x32_bf16 v[60:63], v[40:43], v[52:55], v[60:63]
  s_nop 0
  v_mfma_f32_16x16x32_bf16 v[64:67], v[44:47], v[52:55], v[64:67]
  v_and_b32 v8, 1, v0
  v_lshlrev_b32 v8, 10, v8
  v_bfe_u32 v9, v0, 1, 1
  v_lshl_add_u32 v8, v9, 9, v8
  v_lshrrev_b32 v9, 4, v0
  v_lshl_add_u32 v8, v9, 7, v8
  s_lshl_b32 s4, s3, 11
  v_add_u32 v8, s4, v8
  v_bfe_u32 v9, v0, 2, 2
  v_lshl_add_u32 v8, v9, 4, v8
  v_and_b32 v108, v36, v68
  v_and_b32 v109, v37, v68
  v_and_b32 v110, v38, v68
  v_and_b32 v111, v39, v68
  v_and_b32 v112, v36, v69
  v_and_b32 v113, v37, v69
  v_and_b32 v114, v38, v69
  v_and_b32 v115, v39, v69
  v_and_b32 v116, v36, v70
  v_and_b32 v117, v37, v70
  v_and_b32 v118, v38, v70
  v_and_b32 v119, v39, v70
  v_and_b32 v120, v36, v71
  v_and_b32 v121, v37, v71
  v_and_b32 v122, v38, v71
  v_and_b32 v123, v39, v71
  s_lshl_b32 s4, s3, 10
  v_lshl_add_u32 v10, v0, 4, s4
  v_mov_b32 v25, s60
  v_lshrrev_b32 v24, 8, v25
  v_lshrrev_b32 v26, 24, v25
  v_lshrrev_b32 v27, 16, v25
  v_mov_b32 v12, 1
  v_mov_b32 v9, 4
  s_lshl_b32 s5, s78, 11
  s_add_u32 s6, s5, 1048576
  s_add_u32 s5, s5, 131072
  s_waitcnt lgkmcnt(0)
  v_max3_f32 v20, v16, v17, v18
  v_max_f32 v20, v20, v19
  v_sub_f32 v16, v16, v20
  v_sub_f32 v17, v17, v20
  v_sub_f32 v18, v18, v20
  v_sub_f32 v19, v19, v20
  v_mul_f32 v16, s66, v16
  v_mul_f32 v17, s66, v17
  v_mul_f32 v18, s66, v18
  v_mul_f32 v19, s66, v19
  v_exp_f32 v16, v16
  v_exp_f32 v17, v17
  v_exp_f32 v18, v18
  v_exp_f32 v19, v19
  s_waitcnt vmcnt(6)
  v_perm_b32 v76, v176, v172, s64
  v_perm_b32 v80, v176, v172, s65
  v_perm_b32 v84, v177, v173, s64
  v_perm_b32 v88, v177, v173, s65
  v_perm_b32 v92, v178, v174, s64
  v_perm_b32 v96, v178, v174, s65
  v_perm_b32 v100, v179, v175, s64
  v_perm_b32 v104, v179, v175, s65
  s_waitcnt vmcnt(4)
  v_perm_b32 v77, v184, v180, s64
  v_perm_b32 v81, v184, v180, s65
  v_perm_b32 v85, v185, v181, s64
  v_perm_b32 v89, v185, v181, s65
  v_perm_b32 v93, v186, v182, s64
  v_perm_b32 v97, v186, v182, s65
  v_perm_b32 v101, v187, v183, s64
  v_perm_b32 v105, v187, v183, s65
  s_waitcnt vmcnt(2)
  v_perm_b32 v78, v192, v188, s64
  v_perm_b32 v82, v192, v188, s65
  v_perm_b32 v86, v193, v189, s64
  v_perm_b32 v90, v193, v189, s65
  v_perm_b32 v94, v194, v190, s64
  v_perm_b32 v98, v194, v190, s65
  v_perm_b32 v102, v195, v191, s64
  v_perm_b32 v106, v195, v191, s65
  s_waitcnt vmcnt(0)
  v_perm_b32 v79, v200, v196, s64
  v_perm_b32 v83, v200, v196, s65
  v_perm_b32 v87, v201, v197, s64
  v_perm_b32 v91, v201, v197, s65
  v_perm_b32 v95, v202, v198, s64
  v_perm_b32 v99, v202, v198, s65
  v_perm_b32 v103, v203, v199, s64
  v_perm_b32 v107, v203, v199, s65
  v_mfma_f32_16x16x32_bf16 v[60:63], v[76:79], v[108:111], v[60:63]
  v_mfma_f32_16x16x32_bf16 v[60:63], v[80:83], v[112:115], v[60:63]
  v_mfma_f32_16x16x32_bf16 v[60:63], v[84:87], v[116:119], v[60:63]
  v_mfma_f32_16x16x32_bf16 v[60:63], v[88:91], v[120:123], v[60:63]
  v_mfma_f32_16x16x32_bf16 v[64:67], v[92:95], v[108:111], v[64:67]
  v_mfma_f32_16x16x32_bf16 v[64:67], v[96:99], v[112:115], v[64:67]
  v_mfma_f32_16x16x32_bf16 v[64:67], v[100:103], v[116:119], v[64:67]
  v_mfma_f32_16x16x32_bf16 v[64:67], v[104:107], v[120:123], v[64:67]
  s_nop 3
  ds_write_b128 v8, v[60:63] offset:12288
  s_nop 2
  ds_write_b128 v8, v[64:67] offset:12352
  s_mov_b64 exec, 1
  ds_add_u32 v9, v12
  s_mov_b64 exec, -1
  s_cmp_ge_u32 s3, 2
  s_cbranch_scc1 L_sdone
L_cspin:
  ds_read_b32 v14, v9
  ds_read_b128 v[32:35], v10 offset:12288
  ds_read_b128 v[36:39], v10 offset:14336
  ds_read_b128 v[40:43], v10 offset:16384
  ds_read_b128 v[44:47], v10 offset:18432
  s_waitcnt lgkmcnt(4)
  v_readfirstlane_b32 s4, v14
  s_cmp_lg_u32 s4, 4
  s_cbranch_scc1 L_cspin
  s_waitcnt lgkmcnt(0)
  v_mul_f32 v28, v16, v32
  v_mul_f32 v29, v16, v33
  v_mul_f32 v30, v16, v34
  v_mul_f32 v31, v16, v35
  v_fmac_f32 v28, v17, v36
  v_fmac_f32 v29, v17, v37
  v_fmac_f32 v30, v17, v38
  v_fmac_f32 v31, v17, v39
  v_fmac_f32 v28, v18, v40
  v_fmac_f32 v29, v18, v41
  v_fmac_f32 v30, v18, v42
  v_fmac_f32 v31, v18, v43
  v_fmac_f32 v28, v19, v44
  v_fmac_f32 v29, v19, v45
  v_fmac_f32 v30, v19, v46
  v_fmac_f32 v31, v19, v47
  v_perm_b32 v28, v28, v24, s63
  v_perm_b32 v29, v29, v25, s63
  v_perm_b32 v30, v30, v26, s63
  v_perm_b32 v31, v31, v27, s63
  buffer_store_dwordx4 v[28:31], v10, s[40:43], s6 offen
  buffer_store_dwordx4 v[28:31], v10, s[40:43], s5 offen sc1
L_sdone:
  s_endpgm
L_helper:
  s_sub_u32 s73, s3, 4
  s_bfe_u32 s4, s2, 0x40003
  s_lshl_b32 s68, s4, 0
  s_bfe_u32 s4, s2, 0x30000
  s_lshl_b32 s4, s4, 4
  s_or_b32 s68, s68, s4
  s_bfe_u32 s4, s2, 0x10007
  s_lshl_b32 s4, s4, 7
  s_or_b32 s68, s68, s4
  v_and_b32 v1, 15, v0
  v_lshrrev_b32 v2, 4, v0
  v_and_b32 v3, 31, v0
  v_lshrrev_b32 v4, 5, v0
  v_mul_u32_u24 v5, 896, v4
  v_lshl_add_u32 v5, v3, 5, v5
  v_cmp_gt_u32 s[74:75], 28, v3
  v_mov_b32 v6, 0x10000
  s_nop 0
  v_cndmask_b32 v5, v6, v5, s[74:75]
  v_mov_b32 v6, 0
  v_mov_b32 v7, 0
  ds_write_b32 v7, v6
  ds_write_b32 v7, v6 offset:4
  s_lshl_b32 s4, s73, 5
  v_lshl_add_u32 v19, v2, 3, s4
  s_and_b32 s4, s2, 7
  s_bfe_u32 s5, s2, 0x40003
  s_mov_b32 s79, 0
  s_mov_b32 s7, 0
  s_lshr_b32 s54, s2, 5
  s_lshl_b32 s6, s4, 3
  s_or_b32 s54, s54, s6
  s_bfe_u32 s55, s2, 0x20003
  v_and_b32 v56, 1, v0
  v_lshl_add_u32 v56, v56, 2, v2
  v_lshlrev_b32 v56, 6, v56
  s_lshl_b32 s6, s73, 9
  v_add_u32 v57, s6, v56
  s_waitcnt lgkmcnt(0)
  s_mov_b32 s44, s16
  s_mov_b32 s45, s17
  s_mov_b32 s46, 0x00000700
  s_mov_b32 s47, 0x00020000
  s_mov_b32 s40, s38
  s_mov_b32 s41, s39
  s_mov_b32 s42, 0x00200000
  s_mov_b32 s43, 0x00020000
  s_mov_b32 s48, s24
  s_mov_b32 s49, s25
  s_mov_b32 s50, 0x00380000
  s_mov_b32 s51, 0x00020000
  s_load_dword s76, s[38:39], 0
  buffer_load_dwordx4 v[8:11], v5, s[44:47], 0 offen
  buffer_load_dwordx4 v[12:15], v5, s[44:47], 0 offen offset:16
  s_cmp_ge_u32 s2, 128
  s_cbranch_scc1 L_notq
  s_lshl_b32 s77, s4, 4
  s_add_u32 s77, s77, s5
  s_lshl_b32 s6, s77, 6
  v_mov_b32 v16, s22
  v_mov_b32 v17, s23
  v_lshl_add_u32 v18, v1, 2, s6
  s_mov_b32 s78, 8192
  v_mul_lo_u32 v58, v19, s78
  v_add_u32 v58, v18, v58
  v_mov_b32 v59, 0
  v_lshl_add_u64 v[16:17], v[58:59], 0, v[16:17]
  s_mul_i32 s6, s78, 121
  global_load_dword v64, v[16:17], off
  v_lshl_add_u64 v[16:17], s[78:79], 0, v[16:17]
  global_load_dword v65, v[16:17], off
  v_lshl_add_u64 v[16:17], s[78:79], 0, v[16:17]
  global_load_dword v66, v[16:17], off
  v_lshl_add_u64 v[16:17], s[78:79], 0, v[16:17]
  global_load_dword v67, v[16:17], off
  v_lshl_add_u64 v[16:17], s[78:79], 0, v[16:17]
  global_load_dword v68, v[16:17], off
  v_lshl_add_u64 v[16:17], s[78:79], 0, v[16:17]
  global_load_dword v69, v[16:17], off
  v_lshl_add_u64 v[16:17], s[78:79], 0, v[16:17]
  global_load_dword v70, v[16:17], off
  v_lshl_add_u64 v[16:17], s[78:79], 0, v[16:17]
  global_load_dword v71, v[16:17], off
  v_lshl_add_u64 v[16:17], s[6:7], 0, v[16:17]
  global_load_dword v72, v[16:17], off
  v_lshl_add_u64 v[16:17], s[78:79], 0, v[16:17]
  global_load_dword v73, v[16:17], off
  v_lshl_add_u64 v[16:17], s[78:79], 0, v[16:17]
  global_load_dword v74, v[16:17], off
  v_lshl_add_u64 v[16:17], s[78:79], 0, v[16:17]
  global_load_dword v75, v[16:17], off
  v_lshl_add_u64 v[16:17], s[78:79], 0, v[16:17]
  global_load_dword v76, v[16:17], off
  v_lshl_add_u64 v[16:17], s[78:79], 0, v[16:17]
  global_load_dword v77, v[16:17], off
  v_lshl_add_u64 v[16:17], s[78:79], 0, v[16:17]
  global_load_dword v78, v[16:17], off
  v_lshl_add_u64 v[16:17], s[78:79], 0, v[16:17]
  global_load_dword v79, v[16:17], off
  v_lshl_add_u64 v[16:17], s[6:7], 0, v[16:17]
  global_load_dword v80, v[16:17], off
  v_lshl_add_u64 v[16:17], s[78:79], 0, v[16:17]
  global_load_dword v81, v[16:17], off
  v_lshl_add_u64 v[16:17], s[78:79], 0, v[16:17]
  global_load_dword v82, v[16:17], off
  v_lshl_add_u64 v[16:17], s[78:79], 0, v[16:17]
  global_load_dword v83, v[16:17], off
  v_lshl_add_u64 v[16:17], s[78:79], 0, v[16:17]
  global_load_dword v84, v[16:17], off
  v_lshl_add_u64 v[16:17], s[78:79], 0, v[16:17]
  global_load_dword v85, v[16:17], off
  v_lshl_add_u64 v[16:17], s[78:79], 0, v[16:17]
  global_load_dword v86, v[16:17], off
  v_lshl_add_u64 v[16:17], s[78:79], 0, v[16:17]
  global_load_dword v87, v[16:17], off
  v_lshl_add_u64 v[16:17], s[6:7], 0, v[16:17]
  s_cmp_ge_u32 s73, 2
  s_cbranch_scc1 L_wdonea
  global_load_dword v88, v[16:17], off
  v_lshl_add_u64 v[16:17], s[78:79], 0, v[16:17]
  global_load_dword v89, v[16:17], off
  v_lshl_add_u64 v[16:17], s[78:79], 0, v[16:17]
  global_load_dword v90, v[16:17], off
  v_lshl_add_u64 v[16:17], s[78:79], 0, v[16:17]
  global_load_dword v91, v[16:17], off
  v_lshl_add_u64 v[16:17], s[78:79], 0, v[16:17]
  global_load_dword v92, v[16:17], off
  v_lshl_add_u64 v[16:17], s[78:79], 0, v[16:17]
  global_load_dword v93, v[16:17], off
  v_lshl_add_u64 v[16:17], s[78:79], 0, v[16:17]
  global_load_dword v94, v[16:17], off
  v_lshl_add_u64 v[16:17], s[78:79], 0, v[16:17]
  global_load_dword v95, v[16:17], off
L_wdonea:
  s_barrier
  s_branch L_waitx
L_notq:
  s_barrier
  s_waitcnt vmcnt(0)
  s_cmp_ge_u32 s2, 184
  s_cbranch_scc1 L_j2
  s_mul_i32 s77, s4, 7
  s_add_u32 s77, s77, s5
  s_lshl_b32 s6, s77, 6
  v_cmp_gt_u32 vcc, 8, v1
  v_mov_b32 v16, s30
  v_mov_b32 v17, s31
  v_mov_b32 v20, s28
  v_mov_b32 v21, s29
  v_cndmask_b32 v16, v16, v20, vcc
  v_cndmask_b32 v17, v17, v21, vcc
  v_and_b32 v18, 7, v1
  v_lshl_add_u32 v18, v18, 3, s6
  s_mov_b32 s78, 3584
  s_cmp_eq_u32 s73, 3
  s_cbranch_scc1 L_xrdy
  v_mul_lo_u32 v58, v19, s78
  v_add_u32 v58, v18, v58
  v_mov_b32 v59, 0
  v_lshl_add_u64 v[16:17], v[58:59], 0, v[16:17]
  s_mul_i32 s6, s78, 121
  global_load_dwordx2 v[64:65], v[16:17], off
  v_lshl_add_u64 v[16:17], s[78:79], 0, v[16:17]
  global_load_dwordx2 v[66:67], v[16:17], off
  v_lshl_add_u64 v[16:17], s[78:79], 0, v[16:17]
  global_load_dwordx2 v[68:69], v[16:17], off
  v_lshl_add_u64 v[16:17], s[78:79], 0, v[16:17]
  global_load_dwordx2 v[70:71], v[16:17], off
  v_lshl_add_u64 v[16:17], s[78:79], 0, v[16:17]
  global_load_dwordx2 v[72:73], v[16:17], off
  v_lshl_add_u64 v[16:17], s[78:79], 0, v[16:17]
  global_load_dwordx2 v[74:75], v[16:17], off
  v_lshl_add_u64 v[16:17], s[78:79], 0, v[16:17]
  global_load_dwordx2 v[76:77], v[16:17], off
  v_lshl_add_u64 v[16:17], s[78:79], 0, v[16:17]
  global_load_dwordx2 v[78:79], v[16:17], off
  v_lshl_add_u64 v[16:17], s[6:7], 0, v[16:17]
  global_load_dwordx2 v[80:81], v[16:17], off
  v_lshl_add_u64 v[16:17], s[78:79], 0, v[16:17]
  global_load_dwordx2 v[82:83], v[16:17], off
  v_lshl_add_u64 v[16:17], s[78:79], 0, v[16:17]
  global_load_dwordx2 v[84:85], v[16:17], off
  v_lshl_add_u64 v[16:17], s[78:79], 0, v[16:17]
  global_load_dwordx2 v[86:87], v[16:17], off
  v_lshl_add_u64 v[16:17], s[78:79], 0, v[16:17]
  global_load_dwordx2 v[88:89], v[16:17], off
  v_lshl_add_u64 v[16:17], s[78:79], 0, v[16:17]
  global_load_dwordx2 v[90:91], v[16:17], off
  v_lshl_add_u64 v[16:17], s[78:79], 0, v[16:17]
  global_load_dwordx2 v[92:93], v[16:17], off
  v_lshl_add_u64 v[16:17], s[78:79], 0, v[16:17]
  global_load_dwordx2 v[94:95], v[16:17], off
  v_lshl_add_u64 v[16:17], s[6:7], 0, v[16:17]
  global_load_dwordx2 v[96:97], v[16:17], off
  v_lshl_add_u64 v[16:17], s[78:79], 0, v[16:17]
  global_load_dwordx2 v[98:99], v[16:17], off
  v_lshl_add_u64 v[16:17], s[78:79], 0, v[16:17]
  global_load_dwordx2 v[100:101], v[16:17], off
  v_lshl_add_u64 v[16:17], s[78:79], 0, v[16:17]
  global_load_dwordx2 v[102:103], v[16:17], off
  v_lshl_add_u64 v[16:17], s[78:79], 0, v[16:17]
  global_load_dwordx2 v[104:105], v[16:17], off
  v_lshl_add_u64 v[16:17], s[78:79], 0, v[16:17]
  global_load_dwordx2 v[106:107], v[16:17], off
  v_lshl_add_u64 v[16:17], s[78:79], 0, v[16:17]
  global_load_dwordx2 v[108:109], v[16:17], off
  v_lshl_add_u64 v[16:17], s[78:79], 0, v[16:17]
  global_load_dwordx2 v[110:111], v[16:17], off
  v_lshl_add_u64 v[16:17], s[6:7], 0, v[16:17]
  s_cmp_ge_u32 s73, 2
  s_cbranch_scc1 L_wdoneb
  global_load_dwordx2 v[112:113], v[16:17], off
  v_lshl_add_u64 v[16:17], s[78:79], 0, v[16:17]
  global_load_dwordx2 v[114:115], v[16:17], off
  v_lshl_add_u64 v[16:17], s[78:79], 0, v[16:17]
  global_load_dwordx2 v[116:117], v[16:17], off
  v_lshl_add_u64 v[16:17], s[78:79], 0, v[16:17]
  global_load_dwordx2 v[118:119], v[16:17], off
  v_lshl_add_u64 v[16:17], s[78:79], 0, v[16:17]
  global_load_dwordx2 v[120:121], v[16:17], off
  v_lshl_add_u64 v[16:17], s[78:79], 0, v[16:17]
  global_load_dwordx2 v[122:123], v[16:17], off
  v_lshl_add_u64 v[16:17], s[78:79], 0, v[16:17]
  global_load_dwordx2 v[124:125], v[16:17], off
  v_lshl_add_u64 v[16:17], s[78:79], 0, v[16:17]
  global_load_dwordx2 v[126:127], v[16:17], off
L_wdoneb:
  s_branch L_waitx
L_j2:
  s_sub_u32 s77, s2, 184
  s_cmp_ge_u32 s2, 240
  s_cbranch_scc1 L_nojob
  s_and_b32 s6, s77, 3
  s_mul_i32 s6, s6, 401408
  s_lshr_b32 s5, s77, 2
  s_lshl_b32 s5, s5, 6
  s_add_u32 s6, s6, s5
  v_mov_b32 v16, s32
  v_mov_b32 v17, s33
  v_lshl_add_u32 v18, v1, 2, s6
  s_mov_b32 s78, 896
  v_mul_lo_u32 v58, v19, s78
  v_add_u32 v58, v18, v58
  v_mov_b32 v59, 0
  v_lshl_add_u64 v[16:17], v[58:59], 0, v[16:17]
  s_mul_i32 s6, s78, 121
  global_load_dword v64, v[16:17], off
  v_lshl_add_u64 v[16:17], s[78:79], 0, v[16:17]
  global_load_dword v65, v[16:17], off
  v_lshl_add_u64 v[16:17], s[78:79], 0, v[16:17]
  global_load_dword v66, v[16:17], off
  v_lshl_add_u64 v[16:17], s[78:79], 0, v[16:17]
  global_load_dword v67, v[16:17], off
  v_lshl_add_u64 v[16:17], s[78:79], 0, v[16:17]
  global_load_dword v68, v[16:17], off
  v_lshl_add_u64 v[16:17], s[78:79], 0, v[16:17]
  global_load_dword v69, v[16:17], off
  v_lshl_add_u64 v[16:17], s[78:79], 0, v[16:17]
  global_load_dword v70, v[16:17], off
  v_lshl_add_u64 v[16:17], s[78:79], 0, v[16:17]
  global_load_dword v71, v[16:17], off
  v_lshl_add_u64 v[16:17], s[6:7], 0, v[16:17]
  global_load_dword v72, v[16:17], off
  v_lshl_add_u64 v[16:17], s[78:79], 0, v[16:17]
  global_load_dword v73, v[16:17], off
  v_lshl_add_u64 v[16:17], s[78:79], 0, v[16:17]
  global_load_dword v74, v[16:17], off
  v_lshl_add_u64 v[16:17], s[78:79], 0, v[16:17]
  global_load_dword v75, v[16:17], off
  v_lshl_add_u64 v[16:17], s[78:79], 0, v[16:17]
  global_load_dword v76, v[16:17], off
  v_lshl_add_u64 v[16:17], s[78:79], 0, v[16:17]
  global_load_dword v77, v[16:17], off
  v_lshl_add_u64 v[16:17], s[78:79], 0, v[16:17]
  global_load_dword v78, v[16:17], off
  v_lshl_add_u64 v[16:17], s[78:79], 0, v[16:17]
  global_load_dword v79, v[16:17], off
  v_lshl_add_u64 v[16:17], s[6:7], 0, v[16:17]
  global_load_dword v80, v[16:17], off
  v_lshl_add_u64 v[16:17], s[78:79], 0, v[16:17]
  global_load_dword v81, v[16:17], off
  v_lshl_add_u64 v[16:17], s[78:79], 0, v[16:17]
  global_load_dword v82, v[16:17], off
  v_lshl_add_u64 v[16:17], s[78:79], 0, v[16:17]
  global_load_dword v83, v[16:17], off
  v_lshl_add_u64 v[16:17], s[78:79], 0, v[16:17]
  global_load_dword v84, v[16:17], off
  v_lshl_add_u64 v[16:17], s[78:79], 0, v[16:17]
  global_load_dword v85, v[16:17], off
  v_lshl_add_u64 v[16:17], s[78:79], 0, v[16:17]
  global_load_dword v86, v[16:17], off
  v_lshl_add_u64 v[16:17], s[78:79], 0, v[16:17]
  global_load_dword v87, v[16:17], off
  v_lshl_add_u64 v[16:17], s[6:7], 0, v[16:17]
  s_cmp_ge_u32 s73, 2
  s_cbranch_scc1 L_wdonec
  global_load_dword v88, v[16:17], off
  v_lshl_add_u64 v[16:17], s[78:79], 0, v[16:17]
  global_load_dword v89, v[16:17], off
  v_lshl_add_u64 v[16:17], s[78:79], 0, v[16:17]
  global_load_dword v90, v[16:17], off
  v_lshl_add_u64 v[16:17], s[78:79], 0, v[16:17]
  global_load_dword v91, v[16:17], off
  v_lshl_add_u64 v[16:17], s[78:79], 0, v[16:17]
  global_load_dword v92, v[16:17], off
  v_lshl_add_u64 v[16:17], s[78:79], 0, v[16:17]
  global_load_dword v93, v[16:17], off
  v_lshl_add_u64 v[16:17], s[78:79], 0, v[16:17]
  global_load_dword v94, v[16:17], off
  v_lshl_add_u64 v[16:17], s[78:79], 0, v[16:17]
  global_load_dword v95, v[16:17], off
L_wdonec:
  s_branch L_nojob
L_waitx:
  s_cmp_ge_u32 s73, 2
  s_cbranch_scc1 L_w24
  s_waitcnt vmcnt(32)
  s_branch L_xrdy
L_w24:
  s_waitcnt vmcnt(24)
L_xrdy:
  v_lshlrev_b32 v20, 16, v8
  v_and_b32 v21, s67, v8
  v_lshlrev_b32 v22, 16, v9
  v_and_b32 v23, s67, v9
  v_lshlrev_b32 v24, 16, v10
  v_and_b32 v25, s67, v10
  v_lshlrev_b32 v26, 16, v11
  v_and_b32 v27, s67, v11
  v_lshlrev_b32 v28, 16, v12
  v_and_b32 v29, s67, v12
  v_lshlrev_b32 v30, 16, v13
  v_and_b32 v31, s67, v13
  v_lshlrev_b32 v32, 16, v14
  v_and_b32 v33, s67, v14
  v_lshlrev_b32 v34, 16, v15
  v_and_b32 v35, s67, v15
  v_add_f32 v36, v20, v21
  v_add_f32 v37, v22, v23
  v_add_f32 v38, v24, v25
  v_add_f32 v39, v26, v27
  v_add_f32 v40, v28, v29
  v_add_f32 v41, v30, v31
  v_add_f32 v42, v32, v33
  v_add_f32 v43, v34, v35
  v_add_f32 v36, v36, v40
  v_add_f32 v37, v37, v41
  v_add_f32 v38, v38, v42
  v_add_f32 v39, v39, v43
  v_add_f32 v36, v36, v38
  v_add_f32 v37, v37, v39
  v_add_f32 v36, v36, v37
  s_nop 1
  v_add_f32_dpp v36, v36, v36 row_ror:8 row_mask:0xf bank_mask:0xf
  s_nop 1
  v_add_f32_dpp v36, v36, v36 row_ror:4 row_mask:0xf bank_mask:0xf
  s_nop 1
  v_add_f32_dpp v36, v36, v36 row_ror:2 row_mask:0xf bank_mask:0xf
  s_nop 1
  v_add_f32_dpp v36, v36, v36 row_ror:1 row_mask:0xf bank_mask:0xf
  v_mov_b32 v37, v36
  s_nop 1
  v_permlane16_swap_b32 v36, v37
  v_add_f32 v36, v36, v37
  v_mul_f32 v36, 0x3b124925, v36
  v_sub_f32 v40, v20, v36
  v_sub_f32 v41, v21, v36
  v_sub_f32 v42, v22, v36
  v_sub_f32 v43, v23, v36
  v_sub_f32 v44, v24, v36
  v_sub_f32 v45, v25, v36
  v_sub_f32 v46, v26, v36
  v_sub_f32 v47, v27, v36
  v_sub_f32 v48, v28, v36
  v_sub_f32 v49, v29, v36
  v_sub_f32 v50, v30, v36
  v_sub_f32 v51, v31, v36
  v_sub_f32 v52, v32, v36
  v_sub_f32 v53, v33, v36
  v_sub_f32 v54, v34, v36
  v_sub_f32 v55, v35, v36
  v_mul_f32 v38, v40, v40
  v_mul_f32 v39, v41, v41
  v_fmac_f32 v38, v42, v42
  v_fmac_f32 v39, v43, v43
  v_fmac_f32 v38, v44, v44
  v_fmac_f32 v39, v45, v45
  v_fmac_f32 v38, v46, v46
  v_fmac_f32 v39, v47, v47
  v_fmac_f32 v38, v48, v48
  v_fmac_f32 v39, v49, v49
  v_fmac_f32 v38, v50, v50
  v_fmac_f32 v39, v51, v51
  v_fmac_f32 v38, v52, v52
  v_fmac_f32 v39, v53, v53
  v_fmac_f32 v38, v54, v54
  v_fmac_f32 v39, v55, v55
  v_add_f32 v38, v38, v39
  v_cndmask_b32 v38, 0, v38, s[74:75]
  s_nop 1
  v_add_f32_dpp v38, v38, v38 row_ror:8 row_mask:0xf bank_mask:0xf
  s_nop 1
  v_add_f32_dpp v38, v38, v38 row_ror:4 row_mask:0xf bank_mask:0xf
  s_nop 1
  v_add_f32_dpp v38, v38, v38 row_ror:2 row_mask:0xf bank_mask:0xf
  s_nop 1
  v_add_f32_dpp v38, v38, v38 row_ror:1 row_mask:0xf bank_mask:0xf
  v_mov_b32 v37, v38
  s_nop 1
  v_permlane16_swap_b32 v38, v37
  v_add_f32 v38, v38, v37
  v_mul_f32 v38, 0x3b124925, v38
  v_cvt_pk_bf16_f32 v37, v36, v38
  v_lshlrev_b32 v36, 16, v37
  v_and_b32 v38, s67, v37
  v_add_f32 v38, 0x3727c5ac, v38
  v_cvt_pk_bf16_f32 v38, v38, v38
  v_and_b32 v38, s67, v38
  v_sqrt_f32 v38, v38
  s_nop 0
  v_cvt_pk_bf16_f32 v38, v38, v38
  v_and_b32 v38, s67, v38
  v_rcp_f32 v38, v38
  v_sub_f32 v20, v20, v36
  v_sub_f32 v21, v21, v36
  v_sub_f32 v22, v22, v36
  v_sub_f32 v23, v23, v36
  v_sub_f32 v24, v24, v36
  v_sub_f32 v25, v25, v36
  v_sub_f32 v26, v26, v36
  v_sub_f32 v27, v27, v36
  v_sub_f32 v28, v28, v36
  v_sub_f32 v29, v29, v36
  v_sub_f32 v30, v30, v36
  v_sub_f32 v31, v31, v36
  v_sub_f32 v32, v32, v36
  v_sub_f32 v33, v33, v36
  v_sub_f32 v34, v34, v36
  v_sub_f32 v35, v35, v36
  v_cvt_pk_bf16_f32 v40, v20, v21
  v_cvt_pk_bf16_f32 v41, v22, v23
  v_cvt_pk_bf16_f32 v42, v24, v25
  v_cvt_pk_bf16_f32 v43, v26, v27
  v_cvt_pk_bf16_f32 v44, v28, v29
  v_cvt_pk_bf16_f32 v45, v30, v31
  v_cvt_pk_bf16_f32 v46, v32, v33
  v_cvt_pk_bf16_f32 v47, v34, v35
  v_lshlrev_b32 v20, 16, v40
  v_and_b32 v21, s67, v40
  v_lshlrev_b32 v22, 16, v41
  v_and_b32 v23, s67, v41
  v_lshlrev_b32 v24, 16, v42
  v_and_b32 v25, s67, v42
  v_lshlrev_b32 v26, 16, v43
  v_and_b32 v27, s67, v43
  v_lshlrev_b32 v28, 16, v44
  v_and_b32 v29, s67, v44
  v_lshlrev_b32 v30, 16, v45
  v_and_b32 v31, s67, v45
  v_lshlrev_b32 v32, 16, v46
  v_and_b32 v33, s67, v46
  v_lshlrev_b32 v34, 16, v47
  v_and_b32 v35, s67, v47
  v_mul_f32 v20, v20, v38
  v_mul_f32 v21, v21, v38
  v_mul_f32 v22, v22, v38
  v_mul_f32 v23, v23, v38
  v_mul_f32 v24, v24, v38
  v_mul_f32 v25, v25, v38
  v_mul_f32 v26, v26, v38
  v_mul_f32 v27, v27, v38
  v_mul_f32 v28, v28, v38
  v_mul_f32 v29, v29, v38
  v_mul_f32 v30, v30, v38
  v_mul_f32 v31, v31, v38
  v_mul_f32 v32, v32, v38
  v_mul_f32 v33, v33, v38
  v_mul_f32 v34, v34, v38
  v_mul_f32 v35, v35, v38
  v_cvt_pk_bf16_f32 v40, v20, v21
  v_cvt_pk_bf16_f32 v41, v22, v23
  v_cvt_pk_bf16_f32 v42, v24, v25
  v_cvt_pk_bf16_f32 v43, v26, v27
  v_cvt_pk_bf16_f32 v44, v28, v29
  v_cvt_pk_bf16_f32 v45, v30, v31
  v_cvt_pk_bf16_f32 v46, v32, v33
  v_cvt_pk_bf16_f32 v47, v34, v35
  s_lshl_b32 s4, s73, 11
  v_lshl_add_u32 v36, v0, 5, s4
  ds_write_b128 v36, v[40:43] offset:2048
  ds_write_b128 v36, v[44:47] offset:2064
  v_and_b32 v37, 1, v0
  v_lshlrev_b32 v37, 10, v37
  v_lshl_add_u32 v37, v2, 4, v37
  s_mul_i32 s4, s73, 2112
  v_add_u32 v37, s4, v37
  ds_read_b128 v[20:23], v37 offset:2048
  ds_read_b128 v[24:27], v37 offset:2304
  ds_read_b128 v[28:31], v37 offset:2560
  ds_read_b128 v[32:35], v37 offset:2816
  s_waitcnt lgkmcnt(0)
  s_add_u32 s76, s76, 1
  s_and_b32 s60, s76, 0xff
  s_xor_b32 s61, s60, 0xff
  s_lshl_b32 s61, s61, 8
  s_or_b32 s60, s60, s61
  s_lshr_b32 s61, s76, 8
  s_lshl_b32 s61, s61, 16
  s_or_b32 s60, s60, s61
  s_mov_b32 s61, 0x0c0c0400
  s_mov_b32 s62, 0x04000c0c
  s_mov_b32 s63, 0x07060500
  s_mov_b32 s52, 0xffffff00
  s_cmp_ge_u32 s2, 128
  s_cbranch_scc1 L_gather
  s_waitcnt vmcnt(0)
  v_perm_b32 v40, v65, v64, s64
  v_perm_b32 v41, v67, v66, s64
  v_perm_b32 v42, v69, v68, s64
  v_perm_b32 v43, v71, v70, s64
  v_perm_b32 v44, v65, v64, s65
  v_perm_b32 v45, v67, v66, s65
  v_perm_b32 v46, v69, v68, s65
  v_perm_b32 v47, v71, v70, s65
  v_mfma_f32_16x16x32_bf16 v[128:131], v[40:43], v[20:23], 0
  s_nop 0
  v_mfma_f32_16x16x32_bf16 v[132:135], v[44:47], v[20:23], 0
  v_perm_b32 v40, v73, v72, s64
  v_perm_b32 v41, v75, v74, s64
  v_perm_b32 v42, v77, v76, s64
  v_perm_b32 v43, v79, v78, s64
  v_perm_b32 v44, v73, v72, s65
  v_perm_b32 v45, v75, v74, s65
  v_perm_b32 v46, v77, v76, s65
  v_perm_b32 v47, v79, v78, s65
  v_mfma_f32_16x16x32_bf16 v[128:131], v[40:43], v[24:27], v[128:131]
  s_nop 0
  v_mfma_f32_16x16x32_bf16 v[132:135], v[44:47], v[24:27], v[132:135]
  v_perm_b32 v40, v81, v80, s64
  v_perm_b32 v41, v83, v82, s64
  v_perm_b32 v42, v85, v84, s64
  v_perm_b32 v43, v87, v86, s64
  v_perm_b32 v44, v81, v80, s65
  v_perm_b32 v45, v83, v82, s65
  v_perm_b32 v46, v85, v84, s65
  v_perm_b32 v47, v87, v86, s65
  v_mfma_f32_16x16x32_bf16 v[128:131], v[40:43], v[28:31], v[128:131]
  s_nop 0
  v_mfma_f32_16x16x32_bf16 v[132:135], v[44:47], v[28:31], v[132:135]
  s_cmp_ge_u32 s73, 2
  s_cbranch_scc1 L_kdonea
  v_perm_b32 v40, v89, v88, s64
  v_perm_b32 v41, v91, v90, s64
  v_perm_b32 v42, v93, v92, s64
  v_perm_b32 v43, v95, v94, s64
  v_perm_b32 v44, v89, v88, s65
  v_perm_b32 v45, v91, v90, s65
  v_perm_b32 v46, v93, v92, s65
  v_perm_b32 v47, v95, v94, s65
  v_mfma_f32_16x16x32_bf16 v[128:131], v[40:43], v[32:35], v[128:131]
  s_nop 0
  v_mfma_f32_16x16x32_bf16 v[132:135], v[44:47], v[32:35], v[132:135]
L_kdonea:
  s_mov_b32 exec_lo, 0x00030003
  s_mov_b32 exec_hi, 0x00030003
  v_mov_b32 v6, 1
  s_nop 7
  ds_write_b128 v57, v[128:131] offset:10240
  ds_write_b128 v57, v[132:135] offset:10256
  s_mov_b64 exec, 1
  ds_add_rtn_u32 v6, v7, v6
  s_waitcnt lgkmcnt(0)
  s_mov_b64 exec, -1
  v_readfirstlane_b32 s4, v6
  s_cmp_lg_u32 s4, 3
  s_cbranch_scc1 L_gather
  ds_read_b128 v[64:67], v56 offset:10240
  ds_read_b128 v[68:71], v56 offset:10256
  ds_read_b128 v[72:75], v56 offset:10752
  ds_read_b128 v[76:79], v56 offset:10768
  ds_read_b128 v[80:83], v56 offset:11264
  ds_read_b128 v[84:87], v56 offset:11280
  ds_read_b128 v[88:91], v56 offset:11776
  ds_read_b128 v[92:95], v56 offset:11792
  s_waitcnt lgkmcnt(0)
  v_add_f32 v64, v64, v72
  v_add_f32 v65, v65, v73
  v_add_f32 v66, v66, v74
  v_add_f32 v67, v67, v75
  v_add_f32 v68, v68, v76
  v_add_f32 v69, v69, v77
  v_add_f32 v70, v70, v78
  v_add_f32 v71, v71, v79
  v_add_f32 v80, v80, v88
  v_add_f32 v81, v81, v89
  v_add_f32 v82, v82, v90
  v_add_f32 v83, v83, v91
  v_add_f32 v84, v84, v92
  v_add_f32 v85, v85, v93
  v_add_f32 v86, v86, v94
  v_add_f32 v87, v87, v95
  v_add_f32 v20, v64, v80
  v_add_f32 v21, v65, v81
  v_add_f32 v22, v66, v82
  v_add_f32 v23, v67, v83
  v_add_f32 v24, v68, v84
  v_add_f32 v25, v69, v85
  v_add_f32 v26, v70, v86
  v_add_f32 v27, v71, v87
  v_cvt_pk_bf16_f32 v32, v20, v24
  v_cvt_pk_bf16_f32 v33, v21, v25
  v_cvt_pk_bf16_f32 v34, v22, v26
  v_cvt_pk_bf16_f32 v35, v23, v27
  v_and_b32 v36, 1, v0
  v_lshlrev_b32 v36, 14, v36
  v_lshl_add_u32 v36, v2, 5, v36
  v_and_b32 v37, 2, v0
  v_lshl_add_u32 v36, v37, 3, v36
  v_cndmask_b32 v28, v32, v34, s[70:71]
  v_cndmask_b32 v30, v33, v35, s[70:71]
  v_mov_b32 v29, s76
  v_mov_b32 v31, s76
  s_lshl_b32 s4, s77, 7
  s_add_u32 s4, s4, 4096
  s_mov_b32 exec_lo, 0x000f000f
  s_mov_b32 exec_hi, 0x000f000f
  s_add_u32 s5, s4, 94208
  buffer_store_dwordx4 v[28:31], v36, s[40:43], s5 offen
  buffer_store_dwordx4 v[28:31], v36, s[40:43], s4 offen sc1
  s_mov_b64 exec, -1
  s_branch L_gather
L_ffn:
  s_cmp_lg_u32 s73, 3
  s_cbranch_scc1 L_wdonee
  s_mov_b32 s7, 0
  v_mul_lo_u32 v58, v19, s78
  v_add_u32 v58, v18, v58
  v_mov_b32 v59, 0
  v_lshl_add_u64 v[16:17], v[58:59], 0, v[16:17]
  s_mul_i32 s6, s78, 121
  global_load_dwordx2 v[64:65], v[16:17], off
  v_lshl_add_u64 v[16:17], s[78:79], 0, v[16:17]
  global_load_dwordx2 v[66:67], v[16:17], off
  v_lshl_add_u64 v[16:17], s[78:79], 0, v[16:17]
  global_load_dwordx2 v[68:69], v[16:17], off
  v_lshl_add_u64 v[16:17], s[78:79], 0, v[16:17]
  global_load_dwordx2 v[70:71], v[16:17], off
  v_lshl_add_u64 v[16:17], s[78:79], 0, v[16:17]
  global_load_dwordx2 v[72:73], v[16:17], off
  v_lshl_add_u64 v[16:17], s[78:79], 0, v[16:17]
  global_load_dwordx2 v[74:75], v[16:17], off
  v_lshl_add_u64 v[16:17], s[78:79], 0, v[16:17]
  global_load_dwordx2 v[76:77], v[16:17], off
  v_lshl_add_u64 v[16:17], s[78:79], 0, v[16:17]
  global_load_dwordx2 v[78:79], v[16:17], off
  v_lshl_add_u64 v[16:17], s[6:7], 0, v[16:17]
  global_load_dwordx2 v[80:81], v[16:17], off
  v_lshl_add_u64 v[16:17], s[78:79], 0, v[16:17]
  global_load_dwordx2 v[82:83], v[16:17], off
  v_lshl_add_u64 v[16:17], s[78:79], 0, v[16:17]
  global_load_dwordx2 v[84:85], v[16:17], off
  v_lshl_add_u64 v[16:17], s[78:79], 0, v[16:17]
  global_load_dwordx2 v[86:87], v[16:17], off
  v_lshl_add_u64 v[16:17], s[78:79], 0, v[16:17]
  global_load_dwordx2 v[88:89], v[16:17], off
  v_lshl_add_u64 v[16:17], s[78:79], 0, v[16:17]
  global_load_dwordx2 v[90:91], v[16:17], off
  v_lshl_add_u64 v[16:17], s[78:79], 0, v[16:17]
  global_load_dwordx2 v[92:93], v[16:17], off
  v_lshl_add_u64 v[16:17], s[78:79], 0, v[16:17]
  global_load_dwordx2 v[94:95], v[16:17], off
  v_lshl_add_u64 v[16:17], s[6:7], 0, v[16:17]
  global_load_dwordx2 v[96:97], v[16:17], off
  v_lshl_add_u64 v[16:17], s[78:79], 0, v[16:17]
  global_load_dwordx2 v[98:99], v[16:17], off
  v_lshl_add_u64 v[16:17], s[78:79], 0, v[16:17]
  global_load_dwordx2 v[100:101], v[16:17], off
  v_lshl_add_u64 v[16:17], s[78:79], 0, v[16:17]
  global_load_dwordx2 v[102:103], v[16:17], off
  v_lshl_add_u64 v[16:17], s[78:79], 0, v[16:17]
  global_load_dwordx2 v[104:105], v[16:17], off
  v_lshl_add_u64 v[16:17], s[78:79], 0, v[16:17]
  global_load_dwordx2 v[106:107], v[16:17], off
  v_lshl_add_u64 v[16:17], s[78:79], 0, v[16:17]
  global_load_dwordx2 v[108:109], v[16:17], off
  v_lshl_add_u64 v[16:17], s[78:79], 0, v[16:17]
  global_load_dwordx2 v[110:111], v[16:17], off
  v_lshl_add_u64 v[16:17], s[6:7], 0, v[16:17]
  s_cmp_ge_u32 s73, 2
  s_cbranch_scc1 L_wdonee
  global_load_dwordx2 v[112:113], v[16:17], off
  v_lshl_add_u64 v[16:17], s[78:79], 0, v[16:17]
  global_load_dwordx2 v[114:115], v[16:17], off
  v_lshl_add_u64 v[16:17], s[78:79], 0, v[16:17]
  global_load_dwordx2 v[116:117], v[16:17], off
  v_lshl_add_u64 v[16:17], s[78:79], 0, v[16:17]
  global_load_dwordx2 v[118:119], v[16:17], off
  v_lshl_add_u64 v[16:17], s[78:79], 0, v[16:17]
  global_load_dwordx2 v[120:121], v[16:17], off
  v_lshl_add_u64 v[16:17], s[78:79], 0, v[16:17]
  global_load_dwordx2 v[122:123], v[16:17], off
  v_lshl_add_u64 v[16:17], s[78:79], 0, v[16:17]
  global_load_dwordx2 v[124:125], v[16:17], off
  v_lshl_add_u64 v[16:17], s[78:79], 0, v[16:17]
  global_load_dwordx2 v[126:127], v[16:17], off
L_wdonee:
  s_waitcnt vmcnt(0)
  v_perm_b32 v40, v66, v64, s64
  v_perm_b32 v41, v70, v68, s64
  v_perm_b32 v42, v74, v72, s64
  v_perm_b32 v43, v78, v76, s64
  v_perm_b32 v44, v66, v64, s65
  v_perm_b32 v45, v70, v68, s65
  v_perm_b32 v46, v74, v72, s65
  v_perm_b32 v47, v78, v76, s65
  v_perm_b32 v48, v67, v65, s64
  v_perm_b32 v49, v71, v69, s64
  v_perm_b32 v50, v75, v73, s64
  v_perm_b32 v51, v79, v77, s64
  v_perm_b32 v52, v67, v65, s65
  v_perm_b32 v53, v71, v69, s65
  v_perm_b32 v54, v75, v73, s65
  v_perm_b32 v55, v79, v77, s65
  v_mfma_f32_16x16x32_bf16 v[128:131], v[40:43], v[20:23], 0
  v_mfma_f32_16x16x32_bf16 v[132:135], v[44:47], v[20:23], 0
  v_mfma_f32_16x16x32_bf16 v[136:139], v[48:51], v[20:23], 0
  v_mfma_f32_16x16x32_bf16 v[140:143], v[52:55], v[20:23], 0
  v_perm_b32 v40, v82, v80, s64
  v_perm_b32 v41, v86, v84, s64
  v_perm_b32 v42, v90, v88, s64
  v_perm_b32 v43, v94, v92, s64
  v_perm_b32 v44, v82, v80, s65
  v_perm_b32 v45, v86, v84, s65
  v_perm_b32 v46, v90, v88, s65
  v_perm_b32 v47, v94, v92, s65
  v_perm_b32 v48, v83, v81, s64
  v_perm_b32 v49, v87, v85, s64
  v_perm_b32 v50, v91, v89, s64
  v_perm_b32 v51, v95, v93, s64
  v_perm_b32 v52, v83, v81, s65
  v_perm_b32 v53, v87, v85, s65
  v_perm_b32 v54, v91, v89, s65
  v_perm_b32 v55, v95, v93, s65
  v_mfma_f32_16x16x32_bf16 v[128:131], v[40:43], v[24:27], v[128:131]
  v_mfma_f32_16x16x32_bf16 v[132:135], v[44:47], v[24:27], v[132:135]
  v_mfma_f32_16x16x32_bf16 v[136:139], v[48:51], v[24:27], v[136:139]
  v_mfma_f32_16x16x32_bf16 v[140:143], v[52:55], v[24:27], v[140:143]
  v_perm_b32 v40, v98, v96, s64
  v_perm_b32 v41, v102, v100, s64
  v_perm_b32 v42, v106, v104, s64
  v_perm_b32 v43, v110, v108, s64
  v_perm_b32 v44, v98, v96, s65
  v_perm_b32 v45, v102, v100, s65
  v_perm_b32 v46, v106, v104, s65
  v_perm_b32 v47, v110, v108, s65
  v_perm_b32 v48, v99, v97, s64
  v_perm_b32 v49, v103, v101, s64
  v_perm_b32 v50, v107, v105, s64
  v_perm_b32 v51, v111, v109, s64
  v_perm_b32 v52, v99, v97, s65
  v_perm_b32 v53, v103, v101, s65
  v_perm_b32 v54, v107, v105, s65
  v_perm_b32 v55, v111, v109, s65
  v_mfma_f32_16x16x32_bf16 v[128:131], v[40:43], v[28:31], v[128:131]
  v_mfma_f32_16x16x32_bf16 v[132:135], v[44:47], v[28:31], v[132:135]
  v_mfma_f32_16x16x32_bf16 v[136:139], v[48:51], v[28:31], v[136:139]
  v_mfma_f32_16x16x32_bf16 v[140:143], v[52:55], v[28:31], v[140:143]
  s_cmp_ge_u32 s73, 2
  s_cbranch_scc1 L_kdoneb
  v_perm_b32 v40, v114, v112, s64
  v_perm_b32 v41, v118, v116, s64
  v_perm_b32 v42, v122, v120, s64
  v_perm_b32 v43, v126, v124, s64
  v_perm_b32 v44, v114, v112, s65
  v_perm_b32 v45, v118, v116, s65
  v_perm_b32 v46, v122, v120, s65
  v_perm_b32 v47, v126, v124, s65
  v_perm_b32 v48, v115, v113, s64
  v_perm_b32 v49, v119, v117, s64
  v_perm_b32 v50, v123, v121, s64
  v_perm_b32 v51, v127, v125, s64
  v_perm_b32 v52, v115, v113, s65
  v_perm_b32 v53, v119, v117, s65
  v_perm_b32 v54, v123, v121, s65
  v_perm_b32 v55, v127, v125, s65
  v_mfma_f32_16x16x32_bf16 v[128:131], v[40:43], v[32:35], v[128:131]
  v_mfma_f32_16x16x32_bf16 v[132:135], v[44:47], v[32:35], v[132:135]
  v_mfma_f32_16x16x32_bf16 v[136:139], v[48:51], v[32:35], v[136:139]
  v_mfma_f32_16x16x32_bf16 v[140:143], v[52:55], v[32:35], v[140:143]
L_kdoneb:
  s_mov_b32 exec_lo, 0x00030003
  s_mov_b32 exec_hi, 0x00030003
  v_mov_b32 v6, 1
  s_nop 7
  ds_write_b128 v57, v[128:131] offset:10240
  ds_write_b128 v57, v[132:135] offset:10256
  ds_write_b128 v57, v[136:139] offset:10272
  ds_write_b128 v57, v[140:143] offset:10288
  s_mov_b64 exec, 1
  ds_add_rtn_u32 v6, v7, v6
  s_waitcnt lgkmcnt(0)
  s_mov_b64 exec, -1
  v_readfirstlane_b32 s4, v6
  s_cmp_lg_u32 s4, 3
  s_cbranch_scc1 L_nodown
  ds_read_b128 v[64:67], v56 offset:10240
  ds_read_b128 v[68:71], v56 offset:10256
  ds_read_b128 v[72:75], v56 offset:10272
  ds_read_b128 v[76:79], v56 offset:10288
  ds_read_b128 v[80:83], v56 offset:10752
  ds_read_b128 v[84:87], v56 offset:10768
  ds_read_b128 v[88:91], v56 offset:10784
  ds_read_b128 v[92:95], v56 offset:10800
  ds_read_b128 v[96:99], v56 offset:11264
  ds_read_b128 v[100:103], v56 offset:11280
  ds_read_b128 v[104:107], v56 offset:11296
  ds_read_b128 v[108:111], v56 offset:11312
  ds_read_b128 v[112:115], v56 offset:11776
  ds_read_b128 v[116:119], v56 offset:11792
  ds_read_b128 v[120:123], v56 offset:11808
  ds_read_b128 v[124:127], v56 offset:11824
  s_waitcnt lgkmcnt(0)
  v_add_f32 v64, v64, v80
  v_add_f32 v65, v65, v81
  v_add_f32 v66, v66, v82
  v_add_f32 v67, v67, v83
  v_add_f32 v68, v68, v84
  v_add_f32 v69, v69, v85
  v_add_f32 v70, v70, v86
  v_add_f32 v71, v71, v87
  v_add_f32 v72, v72, v88
  v_add_f32 v73, v73, v89
  v_add_f32 v74, v74, v90
  v_add_f32 v75, v75, v91
  v_add_f32 v76, v76, v92
  v_add_f32 v77, v77, v93
  v_add_f32 v78, v78, v94
  v_add_f32 v79, v79, v95
  v_add_f32 v96, v96, v112
  v_add_f32 v97, v97, v113
  v_add_f32 v98, v98, v114
  v_add_f32 v99, v99, v115
  v_add_f32 v100, v100, v116
  v_add_f32 v101, v101, v117
  v_add_f32 v102, v102, v118
  v_add_f32 v103, v103, v119
  v_add_f32 v104, v104, v120
  v_add_f32 v105, v105, v121
  v_add_f32 v106, v106, v122
  v_add_f32 v107, v107, v123
  v_add_f32 v108, v108, v124
  v_add_f32 v109, v109, v125
  v_add_f32 v110, v110, v126
  v_add_f32 v111, v111, v127
  v_add_f32 v20, v64, v96
  v_add_f32 v21, v65, v97
  v_add_f32 v22, v66, v98
  v_add_f32 v23, v67, v99
  v_add_f32 v24, v68, v100
  v_add_f32 v25, v69, v101
  v_add_f32 v26, v70, v102
  v_add_f32 v27, v71, v103
  v_add_f32 v28, v72, v104
  v_add_f32 v29, v73, v105
  v_add_f32 v30, v74, v106
  v_add_f32 v31, v75, v107
  v_add_f32 v32, v76, v108
  v_add_f32 v33, v77, v109
  v_add_f32 v34, v78, v110
  v_add_f32 v35, v79, v111
  v_mov_b32 v64, v20
  v_mov_b32 v65, v21
  v_mov_b32 v66, v22
  v_mov_b32 v67, v23
  v_mov_b32 v68, v24
  v_mov_b32 v69, v25
  v_mov_b32 v70, v26
  v_mov_b32 v71, v27
  v_mov_b32 v72, v28
  v_mov_b32 v73, v29
  v_mov_b32 v74, v30
  v_mov_b32 v75, v31
  v_mov_b32 v76, v32
  v_mov_b32 v77, v33
  v_mov_b32 v78, v34
  v_mov_b32 v79, v35
  v_permlane32_swap_b32 v20, v64
  v_permlane32_swap_b32 v21, v65
  v_permlane32_swap_b32 v22, v66
  v_permlane32_swap_b32 v23, v67
  v_permlane32_swap_b32 v24, v68
  v_permlane32_swap_b32 v25, v69
  v_permlane32_swap_b32 v26, v70
  v_permlane32_swap_b32 v27, v71
  v_permlane32_swap_b32 v28, v72
  v_permlane32_swap_b32 v29, v73
  v_permlane32_swap_b32 v30, v74
  v_permlane32_swap_b32 v31, v75
  v_permlane32_swap_b32 v32, v76
  v_permlane32_swap_b32 v33, v77
  v_permlane32_swap_b32 v34, v78
  v_permlane32_swap_b32 v35, v79
  v_cvt_pk_bf16_f32 v80, v20, v64
  v_cvt_pk_bf16_f32 v81, v21, v65
  v_cvt_pk_bf16_f32 v82, v22, v66
  v_cvt_pk_bf16_f32 v83, v23, v67
  v_cvt_pk_bf16_f32 v84, v24, v68
  v_cvt_pk_bf16_f32 v85, v25, v69
  v_cvt_pk_bf16_f32 v86, v26, v70
  v_cvt_pk_bf16_f32 v87, v27, v71
  v_cvt_pk_bf16_f32 v88, v28, v72
  v_cvt_pk_bf16_f32 v89, v29, v73
  v_cvt_pk_bf16_f32 v90, v30, v74
  v_cvt_pk_bf16_f32 v91, v31, v75
  v_cvt_pk_bf16_f32 v92, v32, v76
  v_cvt_pk_bf16_f32 v93, v33, v77
  v_cvt_pk_bf16_f32 v94, v34, v78
  v_cvt_pk_bf16_f32 v95, v35, v79
  v_lshlrev_b32 v20, 16, v80
  v_and_b32 v64, s67, v80
  v_lshlrev_b32 v21, 16, v81
  v_and_b32 v65, s67, v81
  v_lshlrev_b32 v22, 16, v82
  v_and_b32 v66, s67, v82
  v_lshlrev_b32 v23, 16, v83
  v_and_b32 v67, s67, v83
  v_lshlrev_b32 v24, 16, v84
  v_and_b32 v68, s67, v84
  v_lshlrev_b32 v25, 16, v85
  v_and_b32 v69, s67, v85
  v_lshlrev_b32 v26, 16, v86
  v_and_b32 v70, s67, v86
  v_lshlrev_b32 v27, 16, v87
  v_and_b32 v71, s67, v87
  v_lshlrev_b32 v28, 16, v88
  v_and_b32 v72, s67, v88
  v_lshlrev_b32 v29, 16, v89
  v_and_b32 v73, s67, v89
  v_lshlrev_b32 v30, 16, v90
  v_and_b32 v74, s67, v90
  v_lshlrev_b32 v31, 16, v91
  v_and_b32 v75, s67, v91
  v_lshlrev_b32 v32, 16, v92
  v_and_b32 v76, s67, v92
  v_lshlrev_b32 v33, 16, v93
  v_and_b32 v77, s67, v93
  v_lshlrev_b32 v34, 16, v94
  v_and_b32 v78, s67, v94
  v_lshlrev_b32 v35, 16, v95
  v_and_b32 v79, s67, v95
  s_mov_b32 s4, 0x3d372713
  s_mov_b32 s5, 0xc0135761
  v_mul_f32 v80, v20, v20
  v_mul_f32 v81, v21, v21
  v_mul_f32 v82, v22, v22
  v_mul_f32 v83, v23, v23
  v_mul_f32 v84, v24, v24
  v_mul_f32 v85, v25, v25
  v_mul_f32 v86, v26, v26
  v_mul_f32 v87, v27, v27
  v_mul_f32 v88, v28, v28
  v_mul_f32 v89, v29, v29
  v_mul_f32 v90, v30, v30
  v_mul_f32 v91, v31, v31
  v_mul_f32 v92, v32, v32
  v_mul_f32 v93, v33, v33
  v_mul_f32 v94, v34, v34
  v_mul_f32 v95, v35, v35
  v_fma_f32 v80, v80, s4, 1.0
  v_fma_f32 v81, v81, s4, 1.0
  v_fma_f32 v82, v82, s4, 1.0
  v_fma_f32 v83, v83, s4, 1.0
  v_fma_f32 v84, v84, s4, 1.0
  v_fma_f32 v85, v85, s4, 1.0
  v_fma_f32 v86, v86, s4, 1.0
  v_fma_f32 v87, v87, s4, 1.0
  v_fma_f32 v88, v88, s4, 1.0
  v_fma_f32 v89, v89, s4, 1.0
  v_fma_f32 v90, v90, s4, 1.0
  v_fma_f32 v91, v91, s4, 1.0
  v_fma_f32 v92, v92, s4, 1.0
  v_fma_f32 v93, v93, s4, 1.0
  v_fma_f32 v94, v94, s4, 1.0
  v_fma_f32 v95, v95, s4, 1.0
  v_mul_f32 v80, v80, v20
  v_mul_f32 v81, v81, v21
  v_mul_f32 v82, v82, v22
  v_mul_f32 v83, v83, v23
  v_mul_f32 v84, v84, v24
  v_mul_f32 v85, v85, v25
  v_mul_f32 v86, v86, v26
  v_mul_f32 v87, v87, v27
  v_mul_f32 v88, v88, v28
  v_mul_f32 v89, v89, v29
  v_mul_f32 v90, v90, v30
  v_mul_f32 v91, v91, v31
  v_mul_f32 v92, v92, v32
  v_mul_f32 v93, v93, v33
  v_mul_f32 v94, v94, v34
  v_mul_f32 v95, v95, v35
  v_mul_f32 v80, s5, v80
  v_mul_f32 v81, s5, v81
  v_mul_f32 v82, s5, v82
  v_mul_f32 v83, s5, v83
  v_mul_f32 v84, s5, v84
  v_mul_f32 v85, s5, v85
  v_mul_f32 v86, s5, v86
  v_mul_f32 v87, s5, v87
  v_mul_f32 v88, s5, v88
  v_mul_f32 v89, s5, v89
  v_mul_f32 v90, s5, v90
  v_mul_f32 v91, s5, v91
  v_mul_f32 v92, s5, v92
  v_mul_f32 v93, s5, v93
  v_mul_f32 v94, s5, v94
  v_mul_f32 v95, s5, v95
  v_exp_f32 v80, v80
  v_exp_f32 v81, v81
  v_exp_f32 v82, v82
  v_exp_f32 v83, v83
  v_exp_f32 v84, v84
  v_exp_f32 v85, v85
  v_exp_f32 v86, v86
  v_exp_f32 v87, v87
  v_exp_f32 v88, v88
  v_exp_f32 v89, v89
  v_exp_f32 v90, v90
  v_exp_f32 v91, v91
  v_exp_f32 v92, v92
  v_exp_f32 v93, v93
  v_exp_f32 v94, v94
  v_exp_f32 v95, v95
  v_add_f32 v80, 1.0, v80
  v_add_f32 v81, 1.0, v81
  v_add_f32 v82, 1.0, v82
  v_add_f32 v83, 1.0, v83
  v_add_f32 v84, 1.0, v84
  v_add_f32 v85, 1.0, v85
  v_add_f32 v86, 1.0, v86
  v_add_f32 v87, 1.0, v87
  v_add_f32 v88, 1.0, v88
  v_add_f32 v89, 1.0, v89
  v_add_f32 v90, 1.0, v90
  v_add_f32 v91, 1.0, v91
  v_add_f32 v92, 1.0, v92
  v_add_f32 v93, 1.0, v93
  v_add_f32 v94, 1.0, v94
  v_add_f32 v95, 1.0, v95
  v_rcp_f32 v80, v80
  v_rcp_f32 v81, v81
  v_rcp_f32 v82, v82
  v_rcp_f32 v83, v83
  v_rcp_f32 v84, v84
  v_rcp_f32 v85, v85
  v_rcp_f32 v86, v86
  v_rcp_f32 v87, v87
  v_rcp_f32 v88, v88
  v_rcp_f32 v89, v89
  v_rcp_f32 v90, v90
  v_rcp_f32 v91, v91
  v_rcp_f32 v92, v92
  v_rcp_f32 v93, v93
  v_rcp_f32 v94, v94
  v_rcp_f32 v95, v95
  v_mul_f32 v80, v80, v20
  v_mul_f32 v81, v81, v21
  v_mul_f32 v82, v82, v22
  v_mul_f32 v83, v83, v23
  v_mul_f32 v84, v84, v24
  v_mul_f32 v85, v85, v25
  v_mul_f32 v86, v86, v26
  v_mul_f32 v87, v87, v27
  v_mul_f32 v88, v88, v28
  v_mul_f32 v89, v89, v29
  v_mul_f32 v90, v90, v30
  v_mul_f32 v91, v91, v31
  v_mul_f32 v92, v92, v32
  v_mul_f32 v93, v93, v33
  v_mul_f32 v94, v94, v34
  v_mul_f32 v95, v95, v35
  v_cvt_pk_bf16_f32 v80, v80, v80
  v_cvt_pk_bf16_f32 v81, v81, v81
  v_cvt_pk_bf16_f32 v82, v82, v82
  v_cvt_pk_bf16_f32 v83, v83, v83
  v_cvt_pk_bf16_f32 v84, v84, v84
  v_cvt_pk_bf16_f32 v85, v85, v85
  v_cvt_pk_bf16_f32 v86, v86, v86
  v_cvt_pk_bf16_f32 v87, v87, v87
  v_cvt_pk_bf16_f32 v88, v88, v88
  v_cvt_pk_bf16_f32 v89, v89, v89
  v_cvt_pk_bf16_f32 v90, v90, v90
  v_cvt_pk_bf16_f32 v91, v91, v91
  v_cvt_pk_bf16_f32 v92, v92, v92
  v_cvt_pk_bf16_f32 v93, v93, v93
  v_cvt_pk_bf16_f32 v94, v94, v94
  v_cvt_pk_bf16_f32 v95, v95, v95
  v_and_b32 v80, s67, v80
  v_and_b32 v81, s67, v81
  v_and_b32 v82, s67, v82
  v_and_b32 v83, s67, v83
  v_and_b32 v84, s67, v84
  v_and_b32 v85, s67, v85
  v_and_b32 v86, s67, v86
  v_and_b32 v87, s67, v87
  v_and_b32 v88, s67, v88
  v_and_b32 v89, s67, v89
  v_and_b32 v90, s67, v90
  v_and_b32 v91, s67, v91
  v_and_b32 v92, s67, v92
  v_and_b32 v93, s67, v93
  v_and_b32 v94, s67, v94
  v_and_b32 v95, s67, v95
  v_mul_f32 v20, v80, v64
  v_mul_f32 v21, v81, v65
  v_mul_f32 v22, v82, v66
  v_mul_f32 v23, v83, v67
  v_mul_f32 v24, v84, v68
  v_mul_f32 v25, v85, v69
  v_mul_f32 v26, v86, v70
  v_mul_f32 v27, v87, v71
  v_mul_f32 v28, v88, v72
  v_mul_f32 v29, v89, v73
  v_mul_f32 v30, v90, v74
  v_mul_f32 v31, v91, v75
  v_mul_f32 v32, v92, v76
  v_mul_f32 v33, v93, v77
  v_mul_f32 v34, v94, v78
  v_mul_f32 v35, v95, v79
  v_cvt_pk_bf16_f32 v64, v20, v24
  v_cvt_pk_bf16_f32 v68, v28, v32
  v_cvt_pk_bf16_f32 v65, v21, v25
  v_cvt_pk_bf16_f32 v69, v29, v33
  v_cvt_pk_bf16_f32 v66, v22, v26
  v_cvt_pk_bf16_f32 v70, v30, v34
  v_cvt_pk_bf16_f32 v67, v23, v27
  v_cvt_pk_bf16_f32 v71, v31, v35
  s_mov_b32 s4, 0xf0f0f0f0
  s_mov_b32 s5, 0xf0f0f0f0
  v_cndmask_b32 v80, v64, v65, s[70:71]
  v_cndmask_b32 v81, v66, v67, s[70:71]
  v_cndmask_b32 v28, v80, v81, s[4:5]
  v_cndmask_b32 v80, v68, v69, s[70:71]
  v_cndmask_b32 v81, v70, v71, s[70:71]
  v_cndmask_b32 v30, v80, v81, s[4:5]
  v_mov_b32 v29, s76
  v_mov_b32 v31, s76
  v_and_b32 v36, 1, v0
  v_lshlrev_b32 v36, 6, v36
  v_lshl_add_u32 v36, v2, 7, v36
  v_and_b32 v37, 6, v0
  v_lshl_add_u32 v36, v37, 3, v36
  s_lshl_b32 s4, s77, 8
  s_add_u32 s4, s4, 36864
  s_mov_b32 exec_lo, 0x00ff00ff
  s_mov_b32 exec_hi, 0
  buffer_store_dwordx4 v[28:31], v36, s[40:43], s4 offen sc1
  s_mov_b64 exec, -1
  s_branch L_nodown
L_nojob:
  s_waitcnt lgkmcnt(0)
  s_add_u32 s76, s76, 1
  s_and_b32 s60, s76, 0xff
  s_xor_b32 s61, s60, 0xff
  s_lshl_b32 s61, s61, 8
  s_or_b32 s60, s60, s61
  s_lshr_b32 s61, s76, 8
  s_lshl_b32 s61, s61, 16
  s_or_b32 s60, s60, s61
  s_mov_b32 s61, 0x0c0c0400
  s_mov_b32 s62, 0x04000c0c
  s_mov_b32 s63, 0x07060500
  s_mov_b32 s52, 0xffffff00
L_gather:
  s_cmp_lg_u32 s73, 3
  s_cbranch_scc1 L_bar1
  s_lshr_b32 s4, s68, 4
  s_lshl_b32 s4, s4, 11
  s_add_u32 s4, s4, 4096
  v_lshlrev_b32 v36, 4, v0
  s_cmp_lt_u32 s2, 128
  s_cbranch_scc1 L_noqd
  s_sleep 40
L_noqd:
  s_sub_u32 s5, s2, 184
  s_cmp_lt_u32 s5, 56
  s_cbranch_scc1 L_noqd2
  s_sleep 40
L_noqd2:
  s_mov_b32 s5, 262144
L_qpoll:
  s_and_b32 s69, s5, 7
  s_cmp_eq_u32 s69, 1
  s_cselect_b32 s69, 0, 94208
  s_add_u32 s69, s69, s4
  buffer_load_dwordx4 v[144:147], v36, s[40:43], s69 offen sc1
  buffer_load_dwordx4 v[148:151], v36, s[40:43], s69 offen offset:1024 sc1
  s_waitcnt vmcnt(0)
  v_xor_b32 v152, s76, v145
  v_xor_b32 v153, s76, v147
  v_xor_b32 v154, s76, v149
  v_xor_b32 v155, s76, v151
  v_or3_b32 v152, v152, v153, v154
  v_or_b32 v152, v152, v155
  v_cmp_ne_u32 vcc, 0, v152
  s_cbranch_vccz L_qpoll_ok
  s_wqm_b64 exec, vcc
  s_sleep 8
  s_sub_u32 s5, s5, 1
  s_cmp_lg_u32 s5, 0
  s_cbranch_scc1 L_qpoll
L_qpoll_ok:
  s_mov_b64 exec, -1
  v_mov_b32 v145, v146
  v_mov_b32 v149, v150
  v_lshlrev_b32 v36, 3, v0
  ds_write_b64 v36, v[144:145] offset:256
  ds_write_b64 v36, v[148:149] offset:768
  s_waitcnt lgkmcnt(0)
  s_barrier
  s_branch L_idle
L_bar1:
  s_barrier
L_idle:
  s_mov_b32 s56, s34
  s_mov_b32 s57, s35
  s_mov_b32 s58, 0x00000700
  s_mov_b32 s59, 0x00020000
  s_cmp_lt_u32 s2, 128
  s_cbranch_scc1 L_nodown
  s_cmp_lt_u32 s2, 184
  s_cbranch_scc1 L_ffn
  s_cmp_lt_u32 s2, 184
  s_cbranch_scc1 L_nodown
  s_cmp_ge_u32 s2, 240
  s_cbranch_scc1 L_nodown
  v_lshrrev_b32 v36, 5, v0
  v_lshlrev_b32 v36, 7, v36
  v_and_b32 v37, 1, v0
  v_lshl_add_u32 v36, v37, 6, v36
  v_and_b32 v37, 1, v2
  v_lshl_add_u32 v36, v37, 5, v36
  s_and_b32 s6, s77, 3
  s_mul_i32 s6, s6, 3584
  s_lshl_b32 s4, s73, 8
  s_add_u32 s6, s6, s4
  s_add_u32 s6, s6, 36864
  s_cmp_ge_u32 s73, 2
  s_cselect_b32 s4, 2, 3
  s_lshl_b32 s4, s4, 10
  s_add_u32 s4, s4, s6
  s_sleep 127
  s_sleep 60
  s_mov_b32 s5, 262144
L_hpoll:
  buffer_load_dwordx4 v[96:99], v36, s[40:43], s6 offen offset:0 sc1
  buffer_load_dwordx4 v[100:103], v36, s[40:43], s6 offen offset:16 sc1
  buffer_load_dwordx4 v[104:107], v36, s[40:43], s6 offen offset:1024 sc1
  buffer_load_dwordx4 v[108:111], v36, s[40:43], s6 offen offset:1040 sc1
  buffer_load_dwordx4 v[112:115], v36, s[40:43], s6 offen offset:2048 sc1
  buffer_load_dwordx4 v[116:119], v36, s[40:43], s6 offen offset:2064 sc1
  buffer_load_dwordx4 v[120:123], v36, s[40:43], s4 offen offset:0 sc1
  buffer_load_dwordx4 v[124:127], v36, s[40:43], s4 offen offset:16 sc1
  s_waitcnt vmcnt(0)
  v_xor_b32 v20, s76, v97
  v_xor_b32 v21, s76, v99
  v_xor_b32 v22, s76, v101
  v_xor_b32 v23, s76, v103
  v_xor_b32 v24, s76, v105
  v_xor_b32 v25, s76, v107
  v_xor_b32 v26, s76, v109
  v_xor_b32 v27, s76, v111
  v_xor_b32 v28, s76, v113
  v_xor_b32 v29, s76, v115
  v_xor_b32 v30, s76, v117
  v_xor_b32 v31, s76, v119
  v_xor_b32 v32, s76, v121
  v_xor_b32 v33, s76, v123
  v_xor_b32 v34, s76, v125
  v_xor_b32 v35, s76, v127
  v_or3_b32 v20, v20, v21, v22
  v_or3_b32 v20, v20, v23, v24
  v_or3_b32 v20, v20, v25, v26
  v_or3_b32 v20, v20, v27, v28
  v_or3_b32 v20, v20, v29, v30
  v_or3_b32 v20, v20, v31, v32
  v_or3_b32 v20, v20, v33, v34
  v_or_b32 v20, v20, v35
  v_cmp_ne_u32 vcc, 0, v20
  s_cbranch_vccz L_hpoll_ok
  s_wqm_b64 exec, vcc
  s_sleep 64
  s_sub_u32 s5, s5, 1
  s_cmp_lg_u32 s5, 0
  s_cbranch_scc1 L_hpoll
L_hpoll_ok:
  s_mov_b64 exec, -1
  v_mov_b32 v20, v96
  v_mov_b32 v21, v98
  v_mov_b32 v22, v100
  v_mov_b32 v23, v102
  v_mov_b32 v24, v104
  v_mov_b32 v25, v106
  v_mov_b32 v26, v108
  v_mov_b32 v27, v110
  v_mov_b32 v28, v112
  v_mov_b32 v29, v114
  v_mov_b32 v30, v116
  v_mov_b32 v31, v118
  v_mov_b32 v32, v120
  v_mov_b32 v33, v122
  v_mov_b32 v34, v124
  v_mov_b32 v35, v126
  v_perm_b32 v40, v65, v64, s64
  v_perm_b32 v41, v67, v66, s64
  v_perm_b32 v42, v69, v68, s64
  v_perm_b32 v43, v71, v70, s64
  v_perm_b32 v44, v65, v64, s65
  v_perm_b32 v45, v67, v66, s65
  v_perm_b32 v46, v69, v68, s65
  v_perm_b32 v47, v71, v70, s65
  v_mfma_f32_16x16x32_bf16 v[128:131], v[40:43], v[20:23], 0
  s_nop 0
  v_mfma_f32_16x16x32_bf16 v[132:135], v[44:47], v[20:23], 0
  v_perm_b32 v40, v73, v72, s64
  v_perm_b32 v41, v75, v74, s64
  v_perm_b32 v42, v77, v76, s64
  v_perm_b32 v43, v79, v78, s64
  v_perm_b32 v44, v73, v72, s65
  v_perm_b32 v45, v75, v74, s65
  v_perm_b32 v46, v77, v76, s65
  v_perm_b32 v47, v79, v78, s65
  v_mfma_f32_16x16x32_bf16 v[128:131], v[40:43], v[24:27], v[128:131]
  s_nop 0
  v_mfma_f32_16x16x32_bf16 v[132:135], v[44:47], v[24:27], v[132:135]
  v_perm_b32 v40, v81, v80, s64
  v_perm_b32 v41, v83, v82, s64
  v_perm_b32 v42, v85, v84, s64
  v_perm_b32 v43, v87, v86, s64
  v_perm_b32 v44, v81, v80, s65
  v_perm_b32 v45, v83, v82, s65
  v_perm_b32 v46, v85, v84, s65
  v_perm_b32 v47, v87, v86, s65
  v_mfma_f32_16x16x32_bf16 v[128:131], v[40:43], v[28:31], v[128:131]
  s_nop 0
  v_mfma_f32_16x16x32_bf16 v[132:135], v[44:47], v[28:31], v[132:135]
  s_cmp_ge_u32 s73, 2
  s_cbranch_scc1 L_kdoned
  v_perm_b32 v40, v89, v88, s64
  v_perm_b32 v41, v91, v90, s64
  v_perm_b32 v42, v93, v92, s64
  v_perm_b32 v43, v95, v94, s64
  v_perm_b32 v44, v89, v88, s65
  v_perm_b32 v45, v91, v90, s65
  v_perm_b32 v46, v93, v92, s65
  v_perm_b32 v47, v95, v94, s65
  v_mfma_f32_16x16x32_bf16 v[128:131], v[40:43], v[32:35], v[128:131]
  s_nop 0
  v_mfma_f32_16x16x32_bf16 v[132:135], v[44:47], v[32:35], v[132:135]
L_kdoned:
  s_mov_b32 exec_lo, 0x00030003
  s_mov_b32 exec_hi, 0x00030003
  v_mov_b32 v6, 1
  s_nop 7
  ds_write_b128 v57, v[128:131] offset:10240
  ds_write_b128 v57, v[132:135] offset:10256
  s_mov_b64 exec, 1
  ds_add_rtn_u32 v6, v7, v6
  s_waitcnt lgkmcnt(0)
  s_mov_b64 exec, -1
  v_readfirstlane_b32 s4, v6
  s_cmp_lg_u32 s4, 3
  s_cbranch_scc1 L_nodown
  ds_read_b128 v[64:67], v56 offset:10240
  ds_read_b128 v[68:71], v56 offset:10256
  ds_read_b128 v[72:75], v56 offset:10752
  ds_read_b128 v[76:79], v56 offset:10768
  ds_read_b128 v[80:83], v56 offset:11264
  ds_read_b128 v[84:87], v56 offset:11280
  ds_read_b128 v[88:91], v56 offset:11776
  ds_read_b128 v[92:95], v56 offset:11792
  s_waitcnt lgkmcnt(0)
  v_add_f32 v64, v64, v72
  v_add_f32 v65, v65, v73
  v_add_f32 v66, v66, v74
  v_add_f32 v67, v67, v75
  v_add_f32 v68, v68, v76
  v_add_f32 v69, v69, v77
  v_add_f32 v70, v70, v78
  v_add_f32 v71, v71, v79
  v_add_f32 v80, v80, v88
  v_add_f32 v81, v81, v89
  v_add_f32 v82, v82, v90
  v_add_f32 v83, v83, v91
  v_add_f32 v84, v84, v92
  v_add_f32 v85, v85, v93
  v_add_f32 v86, v86, v94
  v_add_f32 v87, v87, v95
  v_add_f32 v20, v64, v80
  v_add_f32 v21, v65, v81
  v_add_f32 v22, v66, v82
  v_add_f32 v23, v67, v83
  v_add_f32 v24, v68, v84
  v_add_f32 v25, v69, v85
  v_add_f32 v26, v70, v86
  v_add_f32 v27, v71, v87
  s_mov_b32 s4, 0xf0f0f0f0
  s_mov_b32 s5, 0xf0f0f0f0
  v_cndmask_b32 v32, v20, v21, s[70:71]
  v_cndmask_b32 v33, v22, v23, s[70:71]
  v_cndmask_b32 v28, v32, v33, s[4:5]
  v_cndmask_b32 v32, v24, v25, s[70:71]
  v_cndmask_b32 v33, v26, v27, s[70:71]
  v_cndmask_b32 v30, v32, v33, s[4:5]
  v_mov_b32 v29, s76
  v_mov_b32 v31, s76
  v_and_b32 v36, 1, v0
  v_mul_u32_u24 v36, 3584, v36
  v_lshl_add_u32 v36, v2, 6, v36
  v_and_b32 v37, 6, v0
  v_lshl_add_u32 v36, v37, 3, v36
  s_and_b32 s4, s77, 3
  s_mul_i32 s4, s4, 7168
  s_lshr_b32 s5, s77, 2
  s_lshl_b32 s5, s5, 8
  s_add_u32 s4, s4, s5
  s_add_u32 s4, s4, 53248
  s_mov_b32 exec_lo, 0x00ff00ff
  s_mov_b32 exec_hi, 0x00ff00ff
  buffer_store_dwordx4 v[28:31], v36, s[40:43], s4 offen sc1
  s_mov_b64 exec, -1
L_nodown:
  v_lshrrev_b32 v20, 2, v0
  v_and_b32 v21, 3, v0
  v_lshlrev_b32 v60, 12, v20
  v_lshl_add_u32 v60, v21, 4, v60
  v_and_b32 v61, 1, v0
  v_mul_u32_u24 v61, 896, v61
  s_lshl_b32 s100, s2, 6
  s_add_u32 s100, s100, 655360
  s_lshr_b32 s4, s2, 2
  s_mul_i32 s99, s4, 28
  s_and_b32 s5, s2, 3
  s_lshl_b32 s4, s5, 3
  s_add_u32 s99, s99, s4
  s_cmp_ge_u32 s2, 64
  s_cbranch_scc1 L_prep
  s_cmp_lg_u32 s73, 0
  s_cbranch_scc1 L_prep
  s_lshl_b32 s4, s99, 3
  s_add_u32 s4, s4, 53248
  s_cmp_eq_u32 s5, 3
  s_cselect_b32 s6, 0, 32
  s_add_u32 s6, s6, s4
  s_lshl_b32 s99, s99, 1
  buffer_load_dwordx2 v[44:45], v61, s[44:47], s99 offen
  buffer_load_dwordx2 v[46:47], v61, s[44:47], s99 offen offset:8
  v_and_b32 v22, 3, v20
  v_mul_u32_u24 v22, 7168, v22
  v_lshl_add_u32 v22, v61, 2, v22
  s_sleep 127
  s_sleep 127
  s_sleep 127
  s_mov_b32 s5, 262144
L_fppoll:
  buffer_load_dwordx4 v[64:67], v22, s[40:43], s4 offen offset:0 sc1
  buffer_load_dwordx4 v[68:71], v22, s[40:43], s4 offen offset:16 sc1
  buffer_load_dwordx4 v[72:75], v22, s[40:43], s6 offen offset:0 sc1
  buffer_load_dwordx4 v[76:79], v22, s[40:43], s6 offen offset:16 sc1
  s_waitcnt vmcnt(0)
  v_xor_b32 v24, s76, v65
  v_xor_b32 v25, s76, v67
  v_xor_b32 v26, s76, v69
  v_xor_b32 v27, s76, v71
  v_xor_b32 v28, s76, v73
  v_xor_b32 v29, s76, v75
  v_xor_b32 v30, s76, v77
  v_xor_b32 v31, s76, v79
  v_or3_b32 v24, v24, v25, v26
  v_or3_b32 v24, v24, v27, v28
  v_or3_b32 v24, v24, v29, v30
  v_or_b32 v24, v24, v31
  v_cmp_ne_u32 vcc, 0, v24
  s_cbranch_vccz L_fppoll_ok
  s_wqm_b64 exec, vcc
  s_sleep 100
  s_sub_u32 s5, s5, 1
  s_cmp_lg_u32 s5, 0
  s_cbranch_scc1 L_fppoll
L_fppoll_ok:
  s_mov_b64 exec, -1
  v_cndmask_b32 v80, v64, v66, s[70:71]
  v_cndmask_b32 v81, v68, v70, s[70:71]
  v_cndmask_b32 v82, v72, v74, s[70:71]
  v_cndmask_b32 v83, v76, v78, s[70:71]
  v_add_f32_dpp v80, v80, v80 row_ror:4 row_mask:0xf bank_mask:0xf
  v_add_f32_dpp v81, v81, v81 row_ror:4 row_mask:0xf bank_mask:0xf
  v_add_f32_dpp v82, v82, v82 row_ror:4 row_mask:0xf bank_mask:0xf
  v_add_f32_dpp v83, v83, v83 row_ror:4 row_mask:0xf bank_mask:0xf
  v_add_f32_dpp v72, v80, v80 row_ror:8 row_mask:0xf bank_mask:0xf
  v_add_f32_dpp v73, v81, v81 row_ror:8 row_mask:0xf bank_mask:0xf
  v_add_f32_dpp v74, v82, v82 row_ror:8 row_mask:0xf bank_mask:0xf
  v_add_f32_dpp v75, v83, v83 row_ror:8 row_mask:0xf bank_mask:0xf
  v_cvt_pk_bf16_f32 v72, v72, v72
  v_cvt_pk_bf16_f32 v73, v73, v73
  v_cvt_pk_bf16_f32 v74, v74, v74
  v_cvt_pk_bf16_f32 v75, v75, v75
  v_and_b32 v72, s67, v72
  v_and_b32 v73, s67, v73
  v_and_b32 v74, s67, v74
  v_and_b32 v75, s67, v75
  s_mov_b32 s4, 0xbfb8aa3b
  v_mul_f32 v68, s4, v72
  v_mul_f32 v69, s4, v73
  v_mul_f32 v70, s4, v74
  v_mul_f32 v71, s4, v75
  v_exp_f32 v68, v68
  v_exp_f32 v69, v69
  v_exp_f32 v70, v70
  v_exp_f32 v71, v71
  v_add_f32 v68, 1.0, v68
  v_add_f32 v69, 1.0, v69
  v_add_f32 v70, 1.0, v70
  v_add_f32 v71, 1.0, v71
  v_rcp_f32 v68, v68
  v_rcp_f32 v69, v69
  v_rcp_f32 v70, v70
  v_rcp_f32 v71, v71
  v_mul_f32 v56, v68, v72
  v_mul_f32 v57, v69, v73
  v_mul_f32 v58, v70, v74
  v_mul_f32 v59, v71, v75
  v_cvt_pk_bf16_f32 v56, v56, v56
  v_cvt_pk_bf16_f32 v57, v57, v57
  v_cvt_pk_bf16_f32 v58, v58, v58
  v_cvt_pk_bf16_f32 v59, v59, v59
  v_and_b32 v56, s67, v56
  v_and_b32 v57, s67, v57
  v_and_b32 v58, s67, v58
  v_and_b32 v59, s67, v59
  v_lshlrev_b32 v64, 16, v44
  v_and_b32 v68, s67, v44
  v_lshlrev_b32 v65, 16, v45
  v_and_b32 v69, s67, v45
  v_lshlrev_b32 v66, 16, v46
  v_and_b32 v70, s67, v46
  v_lshlrev_b32 v67, 16, v47
  v_and_b32 v71, s67, v47
  v_cndmask_b32 v52, v64, v68, s[70:71]
  v_cndmask_b32 v53, v65, v69, s[70:71]
  v_cndmask_b32 v54, v66, v70, s[70:71]
  v_cndmask_b32 v55, v67, v71, s[70:71]
L_prep:
  v_lshrrev_b32 v20, 3, v0
  v_and_b32 v21, 7, v0
  v_lshlrev_b32 v22, 11, v20
  v_lshl_add_u32 v22, v21, 4, v22
  v_lshlrev_b32 v23, 4, v20
  s_lshr_b32 s4, s54, 3
  s_and_b32 s6, s73, 1
  s_lshl_b32 s6, s6, 3
  s_add_u32 s4, s4, s6
  s_lshl_b32 s97, s4, 15
  s_add_u32 s97, s97, 131072
  s_and_b32 s6, s54, 7
  s_lshl_b32 s7, s6, 8
  s_add_u32 s97, s97, s7
  s_lshr_b32 s7, s73, 1
  s_lshl_b32 s7, s7, 7
  s_add_u32 s97, s97, s7
  s_add_u32 s101, s97, 16384
  s_lshl_b32 s98, s4, 9
  s_add_u32 s98, s98, 81920
  s_lshr_b32 s6, s6, 2
  s_lshl_b32 s6, s6, 8
  s_add_u32 s98, s98, s6
  s_and_b32 s6, s73, 1
  s_lshl_b32 s6, s6, 7
  s_lshr_b32 s7, s7, 1
  s_add_u32 s6, s6, s7
  v_lshl_add_u32 v36, v21, 3, s6
  v_and_b32 v37, 1, v0
  v_lshlrev_b32 v37, 7, v37
  v_lshl_add_u32 v37, v2, 4, v37
  v_lshlrev_b32 v39, 6, v2
  v_lshl_add_u32 v39, v1, 4, v39
  s_lshl_b32 s96, s54, 2
  s_add_u32 s96, s96, s55
  s_lshl_b32 s96, s96, 10
  s_lshl_b32 s6, s73, 8
  s_add_u32 s96, s96, s6
  s_add_u32 s96, s96, 655360
  v_mov_b32 v38, s76
  v_mov_b32 v193, s60
  v_lshrrev_b32 v192, 8, v193
  v_lshrrev_b32 v194, 24, v193
  v_lshrrev_b32 v195, 16, v193
  s_lshr_b32 s53, s68, 4
  s_lshl_b32 s53, s53, 9
  s_and_b32 s6, s68, 15
  s_lshl_b32 s6, s6, 4
  s_add_u32 s53, s53, s6
  s_add_u32 s53, s53, 81920
  v_and_b32 v35, 1, v0
  v_lshlrev_b32 v34, 8, v35
  v_lshlrev_b32 v35, 3, v35
  v_mov_b32 v50, s76
  v_mov_b32 v51, s76
  s_waitcnt vmcnt(0)
  s_barrier
  s_cmp_lg_u32 s73, 3
  s_cbranch_scc1 L_nostat
  ds_read_b64 v[24:25], v35 offset:20480
  ds_read_b64 v[26:27], v35 offset:20496
  ds_read_b64 v[28:29], v35 offset:20512
  ds_read_b64 v[30:31], v35 offset:20528
  s_waitcnt lgkmcnt(0)
  v_max3_f32 v48, v24, v26, v28
  v_max_f32 v48, v48, v30
  v_sub_f32 v24, v24, v48
  v_sub_f32 v26, v26, v48
  v_sub_f32 v28, v28, v48
  v_sub_f32 v30, v30, v48
  v_mul_f32 v24, s66, v24
  v_mul_f32 v26, s66, v26
  v_mul_f32 v28, s66, v28
  v_mul_f32 v30, s66, v30
  v_exp_f32 v24, v24
  v_exp_f32 v26, v26
  v_exp_f32 v28, v28
  v_exp_f32 v30, v30
  v_mul_f32 v49, v24, v25
  v_fmac_f32 v49, v26, v27
  v_fmac_f32 v49, v28, v29
  v_fmac_f32 v49, v30, v31
  s_mov_b64 exec, 3
  buffer_store_dwordx4 v[48:51], v34, s[40:43], s53 offen sc1
  s_mov_b64 exec, -1
L_nostat:
  s_sleep 127
  s_sleep 127
  s_sleep 127
  s_mov_b32 s7, 262144
L_spoll:
  buffer_load_dwordx4 v[40:43], v23, s[40:43], s98 offen sc1
  buffer_load_dwordx4 v[44:47], v23, s[40:43], s98 offen offset:128 sc1
  s_waitcnt vmcnt(0)
  v_xor_b32 v24, s76, v42
  v_xor_b32 v25, s76, v43
  v_xor_b32 v26, s76, v46
  v_xor_b32 v27, s76, v47
  v_or3_b32 v24, v24, v25, v26
  v_or_b32 v24, v24, v27
  v_cmp_ne_u32 vcc, 0, v24
  s_cbranch_vccz L_spoll_ok
  s_wqm_b64 exec, vcc
  s_sleep 64
  s_sub_u32 s7, s7, 1
  s_cmp_lg_u32 s7, 0
  s_cbranch_scc1 L_spoll
L_spoll_ok:
  s_mov_b64 exec, -1
  v_max_f32 v42, v40, v44
  s_nop 1
  v_max_f32_dpp v42, v42, v42 row_ror:8 row_mask:0xf bank_mask:0xf
  v_mov_b32 v43, v42
  s_nop 1
  v_permlane16_swap_b32 v42, v43
  v_max_f32 v42, v42, v43
  v_mov_b32 v43, v42
  s_nop 1
  v_permlane32_swap_b32 v42, v43
  v_max_f32 v42, v42, v43
  v_sub_f32 v40, v40, v42
  v_sub_f32 v44, v44, v42
  v_mul_f32 v40, s66, v40
  v_mul_f32 v44, s66, v44
  v_exp_f32 v40, v40
  v_exp_f32 v44, v44
  v_mul_f32 v41, v41, v40
  v_fmac_f32 v41, v45, v44
  s_nop 1
  v_add_f32_dpp v41, v41, v41 row_ror:8 row_mask:0xf bank_mask:0xf
  v_mov_b32 v43, v41
  s_nop 1
  v_permlane16_swap_b32 v41, v43
  v_add_f32 v41, v41, v43
  v_mov_b32 v43, v41
  s_nop 1
  v_permlane32_swap_b32 v41, v43
  v_add_f32 v41, v41, v43
  v_rcp_f32 v41, v41
  s_nop 0
  v_mul_f32 v40, v40, v41
  v_mul_f32 v44, v44, v41
  s_barrier
  s_mul_i32 s4, s54, 57344
  s_mul_i32 s5, s55, 224
  s_add_u32 s4, s4, s5
  s_mul_i32 s5, s73, 56
  s_add_u32 s4, s4, s5
  v_mul_u32_u24 v62, 1792, v2
  v_lshl_add_u32 v62, v1, 2, v62
  buffer_load_dword v160, v62, s[48:51], s4 offen offset:0
  buffer_load_dword v164, v62, s[48:51], s4 offen offset:896
  s_add_u32 s4, s4, 7168
  buffer_load_dword v161, v62, s[48:51], s4 offen offset:0
  buffer_load_dword v165, v62, s[48:51], s4 offen offset:896
  s_add_u32 s4, s4, 7168
  buffer_load_dword v162, v62, s[48:51], s4 offen offset:0
  buffer_load_dword v166, v62, s[48:51], s4 offen offset:896
  s_add_u32 s4, s4, 7168
  buffer_load_dword v163, v62, s[48:51], s4 offen offset:0
  buffer_load_dword v167, v62, s[48:51], s4 offen offset:896
  s_add_u32 s4, s4, 7168
  buffer_load_dword v168, v62, s[48:51], s4 offen offset:0
  buffer_load_dword v172, v62, s[48:51], s4 offen offset:896
  s_add_u32 s4, s4, 7168
  buffer_load_dword v169, v62, s[48:51], s4 offen offset:0
  buffer_load_dword v173, v62, s[48:51], s4 offen offset:896
  s_add_u32 s4, s4, 7168
  buffer_load_dword v170, v62, s[48:51], s4 offen offset:0
  buffer_load_dword v174, v62, s[48:51], s4 offen offset:896
  s_add_u32 s4, s4, 7168
  buffer_load_dword v171, v62, s[48:51], s4 offen offset:0
  buffer_load_dword v175, v62, s[48:51], s4 offen offset:896
  s_mov_b32 s7, 0
  s_and_b32 s4, s7, 7
  s_cmp_eq_u32 s4, 1
  s_cselect_b32 s4, 0, 917504
  s_add_u32 s5, s97, s4
  s_add_u32 s6, s101, s4
  buffer_load_dwordx4 v[96:99], v22, s[40:43], s5 offen sc1
  buffer_load_dwordx4 v[100:103], v22, s[40:43], s6 offen sc1
  s_waitcnt vmcnt(0)
  v_perm_b32 v176, v161, v160, s64
  v_perm_b32 v177, v163, v162, s64
  v_perm_b32 v178, v165, v164, s64
  v_perm_b32 v179, v167, v166, s64
  v_perm_b32 v180, v161, v160, s65
  v_perm_b32 v181, v163, v162, s65
  v_perm_b32 v182, v165, v164, s65
  v_perm_b32 v183, v167, v166, s65
  v_perm_b32 v184, v169, v168, s64
  v_perm_b32 v185, v171, v170, s64
  v_perm_b32 v186, v173, v172, s64
  v_perm_b32 v187, v175, v174, s64
  v_perm_b32 v188, v169, v168, s65
  v_perm_b32 v189, v171, v170, s65
  v_perm_b32 v190, v173, v172, s65
  v_perm_b32 v191, v175, v174, s65
  s_mov_b32 s7, 262144
L_ppoll:
  s_and_b32 s4, s7, 7
  s_cmp_eq_u32 s4, 1
  s_cselect_b32 s4, 0, 917504
  s_add_u32 s5, s97, s4
  s_add_u32 s6, s101, s4
  buffer_load_dwordx4 v[96:99], v22, s[40:43], s5 offen sc1
  buffer_load_dwordx4 v[100:103], v22, s[40:43], s6 offen sc1
  s_waitcnt vmcnt(0)
  v_perm_b32 v32, v96, v97, s61
  v_perm_b32 v33, v98, v99, s62
  v_or_b32 v32, v32, v33
  v_xor_b32 v32, s60, v32
  v_perm_b32 v33, v100, v101, s61
  v_perm_b32 v34, v102, v103, s62
  v_or_b32 v33, v33, v34
  v_xor_b32 v33, s60, v33
  v_or_b32 v32, v32, v33
  v_cmp_ne_u32 vcc, 0, v32
  s_cbranch_vccz L_ppoll_ok
  s_wqm_b64 exec, vcc
  s_sleep 1
  s_sub_u32 s7, s7, 1
  s_cmp_lg_u32 s7, 0
  s_cbranch_scc1 L_ppoll
L_ppoll_ok:
  s_mov_b64 exec, -1
  v_and_b32 v24, s52, v96
  v_and_b32 v25, s52, v97
  v_and_b32 v26, s52, v98
  v_and_b32 v27, s52, v99
  v_and_b32 v28, s52, v100
  v_and_b32 v29, s52, v101
  v_and_b32 v30, s52, v102
  v_and_b32 v31, s52, v103
  v_mul_f32 v24, v24, v40
  v_mul_f32 v25, v25, v40
  v_mul_f32 v26, v26, v40
  v_mul_f32 v27, v27, v40
  v_fmac_f32 v24, v28, v44
  v_fmac_f32 v25, v29, v44
  v_fmac_f32 v26, v30, v44
  v_fmac_f32 v27, v31, v44
  v_add_f32_dpp v24, v24, v24 row_ror:8 row_mask:0xf bank_mask:0xf
  v_add_f32_dpp v25, v25, v25 row_ror:8 row_mask:0xf bank_mask:0xf
  v_add_f32_dpp v26, v26, v26 row_ror:8 row_mask:0xf bank_mask:0xf
  v_add_f32_dpp v27, v27, v27 row_ror:8 row_mask:0xf bank_mask:0xf
  v_mov_b32 v28, v24
  v_mov_b32 v29, v25
  v_mov_b32 v30, v26
  v_mov_b32 v31, v27
  v_permlane16_swap_b32 v24, v28
  v_permlane16_swap_b32 v25, v29
  v_permlane16_swap_b32 v26, v30
  v_permlane16_swap_b32 v27, v31
  v_add_f32 v24, v24, v28
  v_add_f32 v25, v25, v29
  v_add_f32 v26, v26, v30
  v_add_f32 v27, v27, v31
  v_mov_b32 v28, v24
  v_mov_b32 v29, v25
  v_mov_b32 v30, v26
  v_mov_b32 v31, v27
  v_permlane32_swap_b32 v24, v28
  v_permlane32_swap_b32 v25, v29
  v_permlane32_swap_b32 v26, v30
  v_permlane32_swap_b32 v27, v31
  v_add_f32 v24, v24, v28
  v_add_f32 v25, v25, v29
  v_add_f32 v26, v26, v30
  v_add_f32 v27, v27, v31
  v_cvt_pk_bf16_f32 v24, v24, v25
  v_cvt_pk_bf16_f32 v25, v26, v27
  s_mov_b64 exec, 0xff
  ds_write_b64 v36, v[24:25] offset:1536
  s_mov_b64 exec, -1
  s_waitcnt lgkmcnt(0)
  s_barrier
  ds_read_b128 v[24:27], v37 offset:1536
  ds_read_b128 v[28:31], v37 offset:1600
  s_waitcnt lgkmcnt(1)
  v_mfma_f32_16x16x32_bf16 v[40:43], v[176:179], v[24:27], 0
  v_mfma_f32_16x16x32_bf16 v[44:47], v[180:183], v[24:27], 0
  s_waitcnt lgkmcnt(0)
  v_mfma_f32_16x16x32_bf16 v[40:43], v[184:187], v[28:31], v[40:43]
  v_mfma_f32_16x16x32_bf16 v[44:47], v[188:191], v[28:31], v[44:47]
  s_nop 7
  v_cndmask_b32 v32, v40, v44, s[70:71]
  v_cndmask_b32 v33, v41, v45, s[70:71]
  v_cndmask_b32 v34, v42, v46, s[70:71]
  v_cndmask_b32 v35, v43, v47, s[70:71]
  v_perm_b32 v32, v32, v192, s63
  v_perm_b32 v33, v33, v193, s63
  v_perm_b32 v34, v34, v194, s63
  v_perm_b32 v35, v35, v195, s63
  s_mov_b32 exec_lo, 0x000f000f
  s_mov_b32 exec_hi, 0x000f000f
  buffer_store_dwordx4 v[32:35], v39, s[40:43], s96 offen sc1
  s_mov_b64 exec, -1
  s_cmp_ge_u32 s2, 64
  s_cbranch_scc1 L_hdone
  s_cmp_lg_u32 s73, 0
  s_cbranch_scc1 L_hdone
  s_add_u32 s4, s100, 65536
  s_add_u32 s5, s100, 131072
  s_add_u32 s6, s100, 196608
  s_sleep 16
  s_mov_b32 s7, 262144
L_fpoll:
  buffer_load_dwordx4 v[104:107], v60, s[40:43], s100 offen sc1
  buffer_load_dwordx4 v[108:111], v60, s[40:43], s4 offen sc1
  buffer_load_dwordx4 v[112:115], v60, s[40:43], s5 offen sc1
  buffer_load_dwordx4 v[116:119], v60, s[40:43], s6 offen sc1
  s_waitcnt vmcnt(0)
  v_perm_b32 v80, v104, v105, s61
  v_perm_b32 v84, v106, v107, s62
  v_or_b32 v80, v80, v84
  v_xor_b32 v80, s60, v80
  v_perm_b32 v81, v108, v109, s61
  v_perm_b32 v84, v110, v111, s62
  v_or_b32 v81, v81, v84
  v_xor_b32 v81, s60, v81
  v_perm_b32 v82, v112, v113, s61
  v_perm_b32 v84, v114, v115, s62
  v_or_b32 v82, v82, v84
  v_xor_b32 v82, s60, v82
  v_perm_b32 v83, v116, v117, s61
  v_perm_b32 v84, v118, v119, s62
  v_or_b32 v83, v83, v84
  v_xor_b32 v83, s60, v83
  v_or3_b32 v80, v80, v81, v82
  v_or_b32 v80, v80, v83
  v_cmp_ne_u32 vcc, 0, v80
  s_cbranch_vccz L_fpoll_ok
  s_wqm_b64 exec, vcc
  s_sleep 1
  s_sub_u32 s7, s7, 1
  s_cmp_lg_u32 s7, 0
  s_cbranch_scc1 L_fpoll
L_fpoll_ok:
  s_mov_b64 exec, -1
  v_and_b32 v64, s52, v104
  v_and_b32 v65, s52, v105
  v_and_b32 v66, s52, v106
  v_and_b32 v67, s52, v107
  v_and_b32 v68, s52, v108
  v_and_b32 v69, s52, v109
  v_and_b32 v70, s52, v110
  v_and_b32 v71, s52, v111
  v_and_b32 v72, s52, v112
  v_and_b32 v73, s52, v113
  v_and_b32 v74, s52, v114
  v_and_b32 v75, s52, v115
  v_and_b32 v76, s52, v116
  v_and_b32 v77, s52, v117
  v_and_b32 v78, s52, v118
  v_and_b32 v79, s52, v119
  v_add_f32 v64, v64, v68
  v_add_f32 v65, v65, v69
  v_add_f32 v66, v66, v70
  v_add_f32 v67, v67, v71
  v_add_f32 v72, v72, v76
  v_add_f32 v73, v73, v77
  v_add_f32 v74, v74, v78
  v_add_f32 v75, v75, v79
  v_add_f32 v64, v64, v72
  v_add_f32 v65, v65, v73
  v_add_f32 v66, v66, v74
  v_add_f32 v67, v67, v75
  v_add_f32_dpp v64, v64, v64 row_ror:4 row_mask:0xf bank_mask:0xf
  v_add_f32_dpp v65, v65, v65 row_ror:4 row_mask:0xf bank_mask:0xf
  v_add_f32_dpp v66, v66, v66 row_ror:4 row_mask:0xf bank_mask:0xf
  v_add_f32_dpp v67, v67, v67 row_ror:4 row_mask:0xf bank_mask:0xf
  v_add_f32_dpp v64, v64, v64 row_ror:8 row_mask:0xf bank_mask:0xf
  v_add_f32_dpp v65, v65, v65 row_ror:8 row_mask:0xf bank_mask:0xf
  v_add_f32_dpp v66, v66, v66 row_ror:8 row_mask:0xf bank_mask:0xf
  v_add_f32_dpp v67, v67, v67 row_ror:8 row_mask:0xf bank_mask:0xf
  v_mov_b32 v68, v64
  v_mov_b32 v69, v65
  v_mov_b32 v70, v66
  v_mov_b32 v71, v67
  v_permlane16_swap_b32 v64, v68
  v_permlane16_swap_b32 v65, v69
  v_permlane16_swap_b32 v66, v70
  v_permlane16_swap_b32 v67, v71
  v_add_f32 v64, v64, v68
  v_add_f32 v65, v65, v69
  v_add_f32 v66, v66, v70
  v_add_f32 v67, v67, v71
  v_mov_b32 v68, v64
  v_mov_b32 v69, v65
  v_mov_b32 v70, v66
  v_mov_b32 v71, v67
  v_permlane32_swap_b32 v64, v68
  v_permlane32_swap_b32 v65, v69
  v_permlane32_swap_b32 v66, v70
  v_permlane32_swap_b32 v67, v71
  v_add_f32 v64, v64, v68
  v_add_f32 v65, v65, v69
  v_add_f32 v66, v66, v70
  v_add_f32 v67, v67, v71
  v_cvt_pk_bf16_f32 v64, v64, v64
  v_cvt_pk_bf16_f32 v65, v65, v65
  v_cvt_pk_bf16_f32 v66, v66, v66
  v_cvt_pk_bf16_f32 v67, v67, v67
  v_and_b32 v64, s67, v64
  v_and_b32 v65, s67, v65
  v_and_b32 v66, s67, v66
  v_and_b32 v67, s67, v67
  v_mul_f32 v64, v64, v56
  v_mul_f32 v65, v65, v57
  v_mul_f32 v66, v66, v58
  v_mul_f32 v67, v67, v59
  v_cvt_pk_bf16_f32 v64, v64, v64
  v_cvt_pk_bf16_f32 v65, v65, v65
  v_cvt_pk_bf16_f32 v66, v66, v66
  v_cvt_pk_bf16_f32 v67, v67, v67
  v_and_b32 v64, s67, v64
  v_and_b32 v65, s67, v65
  v_and_b32 v66, s67, v66
  v_and_b32 v67, s67, v67
  v_add_f32 v64, v64, v52
  v_add_f32 v65, v65, v53
  v_add_f32 v66, v66, v54
  v_add_f32 v67, v67, v55
  v_mov_b32_dpp v68, v64 quad_perm:[2,3,0,1] row_mask:0xf bank_mask:0xf
  v_mov_b32_dpp v69, v65 quad_perm:[2,3,0,1] row_mask:0xf bank_mask:0xf
  v_mov_b32_dpp v70, v66 quad_perm:[2,3,0,1] row_mask:0xf bank_mask:0xf
  v_mov_b32_dpp v71, v67 quad_perm:[2,3,0,1] row_mask:0xf bank_mask:0xf
  v_cvt_pk_bf16_f32 v64, v64, v68
  v_cvt_pk_bf16_f32 v65, v65, v69
  v_cvt_pk_bf16_f32 v66, v66, v70
  v_cvt_pk_bf16_f32 v67, v67, v71
  s_mov_b64 exec, 3
  buffer_store_dwordx2 v[64:65], v61, s[56:59], s99 offen
  s_and_b32 s5, s2, 3
  s_cmp_eq_u32 s5, 3
  s_cbranch_scc1 L_hdone
  buffer_store_dwordx2 v[66:67], v61, s[56:59], s99 offen offset:8
  s_cmp_lg_u32 s2, 0
  s_cbranch_scc1 L_hdone
  s_mov_b64 exec, 1
  buffer_store_dword v38, v61, s[40:43], 0 offen sc1
L_hdone:
L_end:
  s_endpgm
.section .rodata,"a"
.p2align 6
.amdhsa_kernel recurrent_scan__gqa_block_cached__glu_gated_geglu__decode_kernel
  .amdhsa_next_free_vgpr 256
  .amdhsa_next_free_sgpr 102
  .amdhsa_accum_offset 256
  .amdhsa_group_segment_fixed_size 0
  .amdhsa_kernarg_size 96
  .amdhsa_user_sgpr_count 2
  .amdhsa_user_sgpr_kernarg_segment_ptr 1
  .amdhsa_system_sgpr_workgroup_id_x 1
.end_amdhsa_kernel
```
